```python
import torch

def _softmax(x, axis=-1):
    return torch.softmax(x, dim=axis)

def _gelu(x):
    return torch.nn.functional.gelu(x, approximate='tanh')

def _silu(x):
    return torch.nn.functional.silu(x)

def _sigmoid(x):
    return torch.sigmoid(x)

def _layernorm(x, axis=-1, eps=1e-05):
    m = x.mean(dim=axis, keepdim=True)
    v = x.var(dim=axis, keepdim=True, unbiased=False)
    return (x - m) / torch.sqrt(v + eps)

def _scatter_add(tgt, idx, src, axis=0):
    return tgt.clone().index_add_(axis, idx, src)

def _segment_sum(src, seg, n):
    out = torch.zeros((n,) + src.shape[1:], dtype=src.dtype)
    return out.index_add_(0, seg, src)

def _pad(x, pw):
    flat = tuple((v for pair in reversed(pw) for v in pair))
    return torch.nn.functional.pad(x, flat)
kernel_name = 'interleave_layers__spectral_fnet__mixer_gmlp__prompt'

def setup_inputs():

    _w = lambda a: (lambda t: t.to(torch.bfloat16) if t.is_floating_point() else t)(torch.as_tensor(a))

    def _A_setup():
        B, S, D = (1, 2048, 512)
        ns = torch.arange(S)[:, None] * torch.arange(S)[None, :]
        nd = torch.arange(D)[:, None] * torch.arange(D)[None, :]
        Ws_re = torch.cos(-2.0 * torch.pi * ns / S).to(float)
        Ws_im = torch.sin(-2.0 * torch.pi * ns / S).to(float)
        Wd_re = torch.cos(-2.0 * torch.pi * nd / D).to(float)
        Wd_im = torch.sin(-2.0 * torch.pi * nd / D).to(float)
        return {'x': _w((lambda *s: torch.randn(*s, dtype=torch.bfloat16) * 0.05)(B, S, D)), 'dft_seq_re': _w(Ws_re), 'dft_seq_im': _w(Ws_im), 'dft_hid_re': _w(Wd_re), 'dft_hid_im': _w(Wd_im)}
    _A_in = _A_setup()

    def _B_setup():
        B, S, D, F = (1, 2048, 512, 1792)
        Fh = F // 2
        return {'x': _w((lambda *s: torch.randn(*s, dtype=torch.bfloat16) * 0.05)(B, S, D)), 'w_in': _w((lambda *s: torch.randn(*s, dtype=torch.bfloat16) * 1.6)(D, 2 * Fh)), 'w_sp': _w(0.01 * (lambda *s: torch.randn(*s, dtype=torch.bfloat16) * 1.6)(S, S)), 'b_sp': _w(1.0 + 0.01 * (lambda *s: torch.randn(*s, dtype=torch.bfloat16) * 1.6)(S)), 'w_out': _w((lambda *s: torch.randn(*s, dtype=torch.bfloat16) * 1.6)(Fh, D))}
    _B_in = _B_setup()
    return {'A_x': _A_in['x'], 'A_dft_seq_re': _A_in['dft_seq_re'], 'A_dft_seq_im': _A_in['dft_seq_im'], 'A_dft_hid_re': _A_in['dft_hid_re'], 'A_dft_hid_im': _A_in['dft_hid_im'], 'B_x': _B_in['x'], 'B_w_in': _B_in['w_in'], 'B_w_sp': _B_in['w_sp'], 'B_b_sp': _B_in['b_sp'], 'B_w_out': _B_in['w_out']}

def reference(A_x, A_dft_seq_re, A_dft_seq_im, A_dft_hid_re, A_dft_hid_im, B_x, B_w_in, B_w_sp, B_b_sp, B_w_out):

    def _A_ref(x, dft_seq_re, dft_seq_im, dft_hid_re, dft_hid_im):
        a = torch.einsum('bsd,ed->bse', x, dft_hid_re)
        b = torch.einsum('bsd,ed->bse', x, dft_hid_im)
        y = torch.einsum('ts,bse->bte', dft_seq_re, a) - torch.einsum('ts,bse->bte', dft_seq_im, b)
        return y

    def _B_ref(x, w_in, w_sp, b_sp, w_out):
        B, S, D = x.shape
        F = w_in.shape[-1]
        Fh = F // 2
        z = _gelu(torch.einsum('bsd,df->bsf', x, w_in))
        z1 = z[..., :Fh].clone()
        z2 = _layernorm(z[..., Fh:], axis=-1)
        g = torch.einsum('ts,bsf->btf', w_sp, z2) + b_sp[None, :, None]
        return torch.einsum('bsf,fd->bsd', z1 * g, w_out)
    x = A_x
    x = x + _A_ref(_layernorm(x, axis=-1), A_dft_seq_re, A_dft_seq_im, A_dft_hid_re, A_dft_hid_im)
    x = x + _B_ref(_layernorm(x, axis=-1), B_w_in, B_w_sp, B_b_sp, B_w_out)
    x = x + _A_ref(_layernorm(x, axis=-1), A_dft_seq_re, A_dft_seq_im, A_dft_hid_re, A_dft_hid_im)
    x = x + _B_ref(_layernorm(x, axis=-1), B_w_in, B_w_sp, B_b_sp, B_w_out)
    return x
```

```asm
; @launch grid=(256,1,1) block=(256,1,1) lds=163840
.amdgcn_target "amdgcn-amd-amdhsa--gfx950"
.text
.p2align 8
.globl interleave_layers__spectral_fnet__mixer_gmlp__prompt_kernel
.type interleave_layers__spectral_fnet__mixer_gmlp__prompt_kernel,@function
interleave_layers__spectral_fnet__mixer_gmlp__prompt_kernel:
    s_cmp_ge_u32 s2, 256
    s_cbranch_scc1 L_end
    s_load_dwordx16 s[36:51], s[0:1], 0
    s_load_dwordx8 s[52:59], s[0:1], 64
    s_load_dwordx2 s[60:61], s[0:1], 96
    s_getpc_b64 s[86:87]
    v_lshrrev_b32 v12, 6, v0
    v_and_b32 v0, 63, v0
    v_readfirstlane_b32 s62, v12
    s_lshr_b32 s78, s2, 3
    s_and_b32 s78, s78, 7
    s_lshl2_add_u32 s78, s78, s62
    s_lshl_b32 s78, s78, 11
    v_and_b32 v13, 15, v0
    v_lshlrev_b32 v13, 7, v13
    v_add_u32 v13, s78, v13
    v_min_u32 v13, L_end-interleave_layers__spectral_fnet__mixer_gmlp__prompt_kernel-64, v13
    global_load_dword v254, v13, s[86:87]
    v_lshlrev_b32 v1, 4, v0
    v_and_b32 v2, 15, v0
    v_lshrrev_b32 v3, 4, v0
    s_getreg_b32 s70, hwreg(HW_REG_XCC_ID, 0, 3)
    s_and_b32 s63, s2, 7
    s_lshr_b32 s64, s2, 6
    s_bfe_u32 s65, s2, 0x30003
    s_mov_b32 s66, 0
    s_mov_b32 s67, 0x100000
    s_mov_b32 s68, 0
    s_lshr_b32 s74, s2, 3
    s_mul_i32 s69, s62, 7168
    s_mul_i32 s72, s62, 16896
    s_mov_b32 s71, 0x3f803f80
    s_lshl2_add_u32 s80, s63, s64
    s_and_b32 s79, s62, 1
    s_lshl_b32 s79, s79, 5
    s_add_u32 s80, s80, s79
    s_lshr_b32 s79, s62, 1
    s_lshl_b32 s79, s79, 10
    s_add_u32 s80, s80, s79
    s_lshl_b32 s77, s80, 10
    s_lshl2_add_u32 s84, s2, s62
    s_lshr_b32 s78, s62, 1
    s_lshl2_add_u32 s73, s65, s78
    s_lshl_b32 s73, s73, 13
    s_min_u32 s32, s2, 223
    s_mul_i32 s75, s32, 2341
    s_lshr_b32 s75, s75, 16
    s_mul_i32 s79, s75, 28
    s_sub_u32 s76, s32, s79
    s_lshr_b32 s78, s32, 3
    s_and_b32 s79, s78, 7
    s_lshr_b32 s29, s78, 3
    s_mul_i32 s30, s79, 112
    s_lshl_b32 s29, s29, 5
    s_add_u32 s30, s30, s29
    s_mul_i32 s31, s79, 224
    s_add_u32 s31, s31, 96
    s_cmp_lt_u32 s78, 24
    s_cselect_b32 s30, s30, s31
    s_cselect_b32 s31, 16, 112
    s_lshr_b32 s78, s62, 1
    s_mul_i32 s31, s31, s78
    s_add_u32 s30, s30, s31
    s_and_b32 s78, s62, 1
    s_lshl3_add_u32 s30, s78, s30
    s_lshl_b32 s30, s30, 10
    s_and_b32 s78, s32, 7
    s_lshl_b32 s78, s78, 7
    s_add_u32 s30, s30, s78
    s_lshl2_add_u32 s29, s75, s62
    s_mul_i32 s29, s29, 57344
    s_lshl_b32 s78, s76, 7
    s_add_u32 s29, s29, s78
    s_lshl_b32 s31, s62, 11
    s_mul_i32 s32, s62, 1056
    v_lshrrev_b32 v13, 3, v0
    v_and_b32 v15, 7, v0
    v_lshlrev_b32 v15, 4, v15
    v_mul_u32_u24 v62, 3584, v13
    v_add_u32 v62, v62, v15
    v_lshl_add_u32 v63, v13, 10, v15
    s_waitcnt lgkmcnt(0)
    s_mov_b64 s[0:1], s[86:87]
    s_mov_b32 s16, s36
    s_mov_b32 s17, s37
    s_mov_b32 s18, 0x200000
    s_mov_b32 s19, 0x20000
    s_mov_b32 s4, s60
    s_mov_b32 s5, s61
    s_mov_b32 s6, 0x4000000
    s_mov_b32 s7, 0x20000
    s_cmp_lg_u32 s84, 1
    s_cbranch_scc1 L_skip_1
    v_lshlrev_b32 v13, 7, v0
    v_mov_b32 v16, 0
    v_mov_b32 v17, 0
    v_mov_b32 v18, 0
    v_mov_b32 v19, 0
    s_mov_b32 s79, 4096
    buffer_store_dwordx4 v[16:19], v1, s[4:7], 0 offen offset:0 sc1
    buffer_store_dwordx4 v[16:19], v1, s[4:7], 0 offen offset:1024 sc1
    buffer_store_dwordx4 v[16:19], v1, s[4:7], 0 offen offset:2048 sc1
    buffer_store_dwordx4 v[16:19], v1, s[4:7], 0 offen offset:3072 sc1
    buffer_store_dwordx4 v[16:19], v1, s[4:7], s79 offen offset:0 sc1
    buffer_store_dwordx4 v[16:19], v1, s[4:7], s79 offen offset:1024 sc1
    buffer_store_dwordx4 v[16:19], v1, s[4:7], s79 offen offset:2048 sc1
    buffer_store_dwordx4 v[16:19], v1, s[4:7], s79 offen offset:3072 sc1
L_skip_1:
    s_add_u32 s85, s77, 0
    s_add_u32 m0, s72, 0
    s_nop 0
    buffer_load_dwordx4 v1, s[16:19], s85 offen lds
    s_add_u32 s85, s77, 65536
    s_add_u32 m0, s72, 1056
    s_nop 0
    buffer_load_dwordx4 v1, s[16:19], s85 offen lds
    s_add_u32 s85, s77, 131072
    s_add_u32 m0, s72, 2112
    s_nop 0
    buffer_load_dwordx4 v1, s[16:19], s85 offen lds
    s_add_u32 s85, s77, 196608
    s_add_u32 m0, s72, 3168
    s_nop 0
    buffer_load_dwordx4 v1, s[16:19], s85 offen lds
    s_add_u32 s85, s77, 262144
    s_add_u32 m0, s72, 4224
    s_nop 0
    buffer_load_dwordx4 v1, s[16:19], s85 offen lds
    s_add_u32 s85, s77, 327680
    s_add_u32 m0, s72, 5280
    s_nop 0
    buffer_load_dwordx4 v1, s[16:19], s85 offen lds
    s_add_u32 s85, s77, 393216
    s_add_u32 m0, s72, 6336
    s_nop 0
    buffer_load_dwordx4 v1, s[16:19], s85 offen lds
    s_add_u32 s85, s77, 458752
    s_add_u32 m0, s72, 7392
    s_nop 0
    buffer_load_dwordx4 v1, s[16:19], s85 offen lds
    s_add_u32 s85, s77, 524288
    s_add_u32 m0, s72, 8448
    s_nop 0
    buffer_load_dwordx4 v1, s[16:19], s85 offen lds
    s_add_u32 s85, s77, 589824
    s_add_u32 m0, s72, 9504
    s_nop 0
    buffer_load_dwordx4 v1, s[16:19], s85 offen lds
    s_add_u32 s85, s77, 655360
    s_add_u32 m0, s72, 10560
    s_nop 0
    buffer_load_dwordx4 v1, s[16:19], s85 offen lds
    s_add_u32 s85, s77, 720896
    s_add_u32 m0, s72, 11616
    s_nop 0
    buffer_load_dwordx4 v1, s[16:19], s85 offen lds
    s_add_u32 s85, s77, 786432
    s_add_u32 m0, s72, 12672
    s_nop 0
    buffer_load_dwordx4 v1, s[16:19], s85 offen lds
    s_add_u32 s85, s77, 851968
    s_add_u32 m0, s72, 13728
    s_nop 0
    buffer_load_dwordx4 v1, s[16:19], s85 offen lds
    s_add_u32 s85, s77, 917504
    s_add_u32 m0, s72, 14784
    s_nop 0
    buffer_load_dwordx4 v1, s[16:19], s85 offen lds
    s_add_u32 s85, s77, 983040
    s_add_u32 m0, s72, 15840
    s_nop 0
    buffer_load_dwordx4 v1, s[16:19], s85 offen lds
    s_mov_b32 s12, s48
    s_mov_b32 s13, s49
    s_mov_b32 s14, 0x1c0000
    s_mov_b32 s15, 0x20000
    s_mov_b32 s20, s54
    s_mov_b32 s21, s55
    s_mov_b32 s22, 0xe0000
    s_mov_b32 s23, 0x20000
    s_mov_b32 s24, s58
    s_mov_b32 s25, s59
    s_mov_b32 s26, 0x100
    s_mov_b32 s27, 0x20000
    s_bitcmp1_b32 s62, 0
    s_cselect_b32 s8, s44, s42
    s_cselect_b32 s9, s45, s43
    s_mov_b32 s10, 524288
    s_mov_b32 s11, 0x20000
    s_and_b32 s78, s62, 1
    s_lshr_b32 s79, s62, 1
    s_lshl1_add_u32 s78, s78, s79
    s_mul_i32 s60, s78, 4224
    v_lshrrev_b32 v12, 5, v0
    v_and_b32 v252, 31, v0
    v_lshlrev_b32 v252, 4, v252
    v_lshl_add_u32 v252, v12, 14, v252
    s_add_u32 s85, s73, 2048
    s_add_u32 m0, s60, 142080
    s_nop 0
    buffer_load_dwordx4 v252, s[8:11], s85 offen lds
    s_add_u32 s85, s73, 4096
    s_add_u32 m0, s60, 143136
    s_nop 0
    buffer_load_dwordx4 v252, s[8:11], s85 offen lds
    s_add_u32 s85, s73, 6144
    s_add_u32 m0, s60, 144192
    s_nop 0
    buffer_load_dwordx4 v252, s[8:11], s85 offen lds
    s_add_u32 s85, s73, 8192
    s_add_u32 m0, s60, 145248
    s_nop 0
    buffer_load_dwordx4 v252, s[8:11], s85 offen lds
    s_add_u32 s85, s73, 1024
    s_add_u32 m0, s60, 125184
    s_nop 0
    buffer_load_dwordx4 v252, s[8:11], s85 offen lds
    s_add_u32 s85, s73, 3072
    s_add_u32 m0, s60, 126240
    s_nop 0
    buffer_load_dwordx4 v252, s[8:11], s85 offen lds
    s_add_u32 s85, s73, 5120
    s_add_u32 m0, s60, 127296
    s_nop 0
    buffer_load_dwordx4 v252, s[8:11], s85 offen lds
    s_add_u32 s85, s73, 7168
    s_add_u32 m0, s60, 128352
    s_nop 0
    buffer_load_dwordx4 v252, s[8:11], s85 offen lds
    s_cmp_lg_u32 s84, 1
    s_cbranch_scc1 L_skip_2
    s_waitcnt vmcnt(24)
    v_mov_b32 v13, 1
    s_mov_b64 exec, 1
    buffer_store_dword v13, off, s[24:27], 0 offset:8 sc1
    s_mov_b64 exec, -1
    v_and_b32 v13, 1, v0
    v_mul_u32_u24 v13, 6291456, v13
    v_lshrrev_b32 v14, 1, v0
    v_lshl_add_u32 v13, v14, 2, v13
    s_mov_b32 s79, 10485632
    buffer_store_dword v16, v13, s[4:7], s79 offen sc1
    s_mov_b32 s79, 16384
    buffer_store_dwordx4 v[16:19], v1, s[4:7], s79 offen offset:0 sc1
    buffer_store_dwordx4 v[16:19], v1, s[4:7], s79 offen offset:1024 sc1
    buffer_store_dwordx4 v[16:19], v1, s[4:7], s79 offen offset:2048 sc1
    buffer_store_dwordx4 v[16:19], v1, s[4:7], s79 offen offset:3072 sc1
L_skip_2:
    s_mov_b32 s77, 0
    s_add_u32 m0, s31, 67584
    s_nop 0
    buffer_load_dwordx4 v62, s[12:15], s29 offen lds
    s_add_u32 s29, s29, 28672
    s_add_u32 m0, s31, 68608
    s_nop 0
    buffer_load_dwordx4 v62, s[12:15], s29 offen lds
    s_add_u32 m0, s32, 75776
    s_nop 0
    buffer_load_dwordx4 v63, s[20:23], s30 offen lds
    s_mov_b32 s12, s50
    s_mov_b32 s13, s51
    s_mov_b32 s14, 0x800000
    s_mov_b32 s15, 0x20000
    s_mov_b32 s20, s56
    s_mov_b32 s21, s57
    s_mov_b32 s22, 0x200000
    s_mov_b32 s23, 0x20000
    v_and_b32 v12, 7, v2
    v_mul_u32_u24 v7, 1056, v12
    v_lshrrev_b32 v12, 3, v2
    v_lshl_add_u32 v7, v12, 9, v7
    v_lshl_add_u32 v7, v3, 4, v7
    v_add_u32 v7, 125184, v7
    v_lshlrev_b32 v10, 17, v3
    v_lshl_add_u32 v10, v2, 4, v10
    s_lshl2_add_u32 s79, s63, s64
    s_lshl3_add_u32 s79, s79, s65
    s_lshl_b32 s79, s79, 8
    s_lshl_b32 s28, s62, 19
    s_add_u32 s28, s28, s79
    s_add_u32 s28, s28, 10485760
    v_mov_b32 v188, -1
    v_mov_b32 v192, 0
    v_mov_b32 v189, -1
    v_mov_b32 v193, 0
    v_mov_b32 v190, -1
    v_mov_b32 v194, 0
    v_mov_b32 v191, -1
    v_mov_b32 v195, 0
    s_lshl_b32 s82, s84, 9
    s_add_u32 s83, s82, 262144
    s_add_u32 s82, s82, 32768
    s_cmp_lt_u32 s84, 32
    s_cselect_b32 s82, s82, 1073741824
    s_mov_b32 exec_hi, 0
    buffer_store_dwordx4 v[188:191], v1, s[4:7], s83 offen sc1
    buffer_store_dwordx4 v[192:195], v1, s[4:7], s82 offen sc1
    s_mov_b64 exec, -1
    s_lshr_b32 s78, s2, 3
    s_lshr_b32 s79, s62, 1
    s_lshl1_add_u32 s78, s78, s79
    s_lshl3_add_u32 s78, s78, s70
    s_lshl_b32 s61, s78, 14
    s_and_b32 s79, s62, 1
    s_lshl_b32 s79, s79, 1
    v_lshrrev_b32 v13, 3, v2
    v_add_u32 v13, s79, v13
    v_sub_u32 v14, v13, v3
    v_and_b32 v14, 3, v14
    v_lshlrev_b32 v58, 12, v13
    v_lshl_add_u32 v58, v14, 10, v58
    v_and_b32 v13, 7, v2
    v_lshl_add_u32 v58, v13, 7, v58
    v_mul_u32_u24 v12, 1056, v2
    v_lshl_add_u32 v12, v3, 4, v12
    v_add_u32 v12, s72, v12
    v_mov_b32 v54, 0
    v_mov_b32 v55, 0
    s_waitcnt vmcnt(13)
    ds_read_b128 v[64:67], v12 offset:0
    ds_read_b128 v[68:71], v12 offset:512
    ds_read_b128 v[72:75], v12 offset:64
    ds_read_b128 v[76:79], v12 offset:576
    ds_read_b128 v[80:83], v12 offset:128
    ds_read_b128 v[84:87], v12 offset:640
    ds_read_b128 v[88:91], v12 offset:192
    ds_read_b128 v[92:95], v12 offset:704
    ds_read_b128 v[96:99], v12 offset:256
    ds_read_b128 v[100:103], v12 offset:768
    ds_read_b128 v[104:107], v12 offset:320
    ds_read_b128 v[108:111], v12 offset:832
    ds_read_b128 v[112:115], v12 offset:384
    ds_read_b128 v[116:119], v12 offset:896
    ds_read_b128 v[120:123], v12 offset:448
    ds_read_b128 v[124:127], v12 offset:960
    s_add_u32 s83, s28, 0x10000
    buffer_store_dwordx4 v[188:191], v10, s[4:7], s28 offen sc1
    buffer_store_dwordx4 v[188:191], v10, s[4:7], s83 offen sc1
    s_mov_b32 exec_lo, 0xffff
    s_mov_b32 exec_hi, 0x0
    buffer_load_dword v254, v58, s[12:15], s61 offen offset:0
    s_mov_b64 exec, -1
    s_waitcnt lgkmcnt(15)
    v_dot2c_f32_bf16 v54, s71, v64
    v_dot2c_f32_bf16 v55, v64, v64
    v_dot2c_f32_bf16 v54, s71, v65
    v_dot2c_f32_bf16 v55, v65, v65
    v_dot2c_f32_bf16 v54, s71, v66
    v_dot2c_f32_bf16 v55, v66, v66
    v_dot2c_f32_bf16 v54, s71, v67
    v_dot2c_f32_bf16 v55, v67, v67
    s_waitcnt lgkmcnt(14)
    v_dot2c_f32_bf16 v54, s71, v68
    v_dot2c_f32_bf16 v55, v68, v68
    v_dot2c_f32_bf16 v54, s71, v69
    v_dot2c_f32_bf16 v55, v69, v69
    v_dot2c_f32_bf16 v54, s71, v70
    v_dot2c_f32_bf16 v55, v70, v70
    v_dot2c_f32_bf16 v54, s71, v71
    v_dot2c_f32_bf16 v55, v71, v71
    s_waitcnt lgkmcnt(13)
    v_dot2c_f32_bf16 v54, s71, v72
    v_dot2c_f32_bf16 v55, v72, v72
    v_dot2c_f32_bf16 v54, s71, v73
    v_dot2c_f32_bf16 v55, v73, v73
    v_dot2c_f32_bf16 v54, s71, v74
    v_dot2c_f32_bf16 v55, v74, v74
    v_dot2c_f32_bf16 v54, s71, v75
    v_dot2c_f32_bf16 v55, v75, v75
    s_waitcnt lgkmcnt(12)
    v_dot2c_f32_bf16 v54, s71, v76
    v_dot2c_f32_bf16 v55, v76, v76
    v_dot2c_f32_bf16 v54, s71, v77
    v_dot2c_f32_bf16 v55, v77, v77
    v_dot2c_f32_bf16 v54, s71, v78
    v_dot2c_f32_bf16 v55, v78, v78
    v_dot2c_f32_bf16 v54, s71, v79
    v_dot2c_f32_bf16 v55, v79, v79
    s_waitcnt lgkmcnt(11)
    v_dot2c_f32_bf16 v54, s71, v80
    v_dot2c_f32_bf16 v55, v80, v80
    v_dot2c_f32_bf16 v54, s71, v81
    v_dot2c_f32_bf16 v55, v81, v81
    v_dot2c_f32_bf16 v54, s71, v82
    v_dot2c_f32_bf16 v55, v82, v82
    v_dot2c_f32_bf16 v54, s71, v83
    v_dot2c_f32_bf16 v55, v83, v83
    s_waitcnt lgkmcnt(10)
    v_dot2c_f32_bf16 v54, s71, v84
    v_dot2c_f32_bf16 v55, v84, v84
    v_dot2c_f32_bf16 v54, s71, v85
    v_dot2c_f32_bf16 v55, v85, v85
    v_dot2c_f32_bf16 v54, s71, v86
    v_dot2c_f32_bf16 v55, v86, v86
    v_dot2c_f32_bf16 v54, s71, v87
    v_dot2c_f32_bf16 v55, v87, v87
    s_waitcnt lgkmcnt(9)
    v_dot2c_f32_bf16 v54, s71, v88
    v_dot2c_f32_bf16 v55, v88, v88
    v_dot2c_f32_bf16 v54, s71, v89
    v_dot2c_f32_bf16 v55, v89, v89
    v_dot2c_f32_bf16 v54, s71, v90
    v_dot2c_f32_bf16 v55, v90, v90
    v_dot2c_f32_bf16 v54, s71, v91
    v_dot2c_f32_bf16 v55, v91, v91
    s_waitcnt lgkmcnt(8)
    v_dot2c_f32_bf16 v54, s71, v92
    v_dot2c_f32_bf16 v55, v92, v92
    v_dot2c_f32_bf16 v54, s71, v93
    v_dot2c_f32_bf16 v55, v93, v93
    v_dot2c_f32_bf16 v54, s71, v94
    v_dot2c_f32_bf16 v55, v94, v94
    v_dot2c_f32_bf16 v54, s71, v95
    v_dot2c_f32_bf16 v55, v95, v95
    s_waitcnt lgkmcnt(7)
    v_dot2c_f32_bf16 v54, s71, v96
    v_dot2c_f32_bf16 v55, v96, v96
    v_dot2c_f32_bf16 v54, s71, v97
    v_dot2c_f32_bf16 v55, v97, v97
    v_dot2c_f32_bf16 v54, s71, v98
    v_dot2c_f32_bf16 v55, v98, v98
    v_dot2c_f32_bf16 v54, s71, v99
    v_dot2c_f32_bf16 v55, v99, v99
    s_waitcnt lgkmcnt(6)
    v_dot2c_f32_bf16 v54, s71, v100
    v_dot2c_f32_bf16 v55, v100, v100
    v_dot2c_f32_bf16 v54, s71, v101
    v_dot2c_f32_bf16 v55, v101, v101
    v_dot2c_f32_bf16 v54, s71, v102
    v_dot2c_f32_bf16 v55, v102, v102
    v_dot2c_f32_bf16 v54, s71, v103
    v_dot2c_f32_bf16 v55, v103, v103
    s_waitcnt lgkmcnt(5)
    v_dot2c_f32_bf16 v54, s71, v104
    v_dot2c_f32_bf16 v55, v104, v104
    v_dot2c_f32_bf16 v54, s71, v105
    v_dot2c_f32_bf16 v55, v105, v105
    v_dot2c_f32_bf16 v54, s71, v106
    v_dot2c_f32_bf16 v55, v106, v106
    v_dot2c_f32_bf16 v54, s71, v107
    v_dot2c_f32_bf16 v55, v107, v107
    s_waitcnt lgkmcnt(4)
    v_dot2c_f32_bf16 v54, s71, v108
    v_dot2c_f32_bf16 v55, v108, v108
    v_dot2c_f32_bf16 v54, s71, v109
    v_dot2c_f32_bf16 v55, v109, v109
    v_dot2c_f32_bf16 v54, s71, v110
    v_dot2c_f32_bf16 v55, v110, v110
    v_dot2c_f32_bf16 v54, s71, v111
    v_dot2c_f32_bf16 v55, v111, v111
    s_waitcnt lgkmcnt(3)
    v_dot2c_f32_bf16 v54, s71, v112
    v_dot2c_f32_bf16 v55, v112, v112
    v_dot2c_f32_bf16 v54, s71, v113
    v_dot2c_f32_bf16 v55, v113, v113
    v_dot2c_f32_bf16 v54, s71, v114
    v_dot2c_f32_bf16 v55, v114, v114
    v_dot2c_f32_bf16 v54, s71, v115
    v_dot2c_f32_bf16 v55, v115, v115
    s_waitcnt lgkmcnt(2)
    v_dot2c_f32_bf16 v54, s71, v116
    v_dot2c_f32_bf16 v55, v116, v116
    v_dot2c_f32_bf16 v54, s71, v117
    v_dot2c_f32_bf16 v55, v117, v117
    v_dot2c_f32_bf16 v54, s71, v118
    v_dot2c_f32_bf16 v55, v118, v118
    v_dot2c_f32_bf16 v54, s71, v119
    v_dot2c_f32_bf16 v55, v119, v119
    s_waitcnt lgkmcnt(1)
    v_dot2c_f32_bf16 v54, s71, v120
    v_dot2c_f32_bf16 v55, v120, v120
    v_dot2c_f32_bf16 v54, s71, v121
    v_dot2c_f32_bf16 v55, v121, v121
    v_dot2c_f32_bf16 v54, s71, v122
    v_dot2c_f32_bf16 v55, v122, v122
    v_dot2c_f32_bf16 v54, s71, v123
    v_dot2c_f32_bf16 v55, v123, v123
    s_waitcnt lgkmcnt(0)
    v_dot2c_f32_bf16 v54, s71, v124
    v_dot2c_f32_bf16 v55, v124, v124
    v_dot2c_f32_bf16 v54, s71, v125
    v_dot2c_f32_bf16 v55, v125, v125
    v_dot2c_f32_bf16 v54, s71, v126
    v_dot2c_f32_bf16 v55, v126, v126
    v_dot2c_f32_bf16 v54, s71, v127
    v_dot2c_f32_bf16 v55, v127, v127
    s_nop 2
    v_permlane32_swap_b32 v54, v55
    v_add_f32 v54, v54, v55
    v_mov_b32 v55, v54
    s_nop 1
    v_permlane16_swap_b32 v54, v55
    v_add_f32 v54, v54, v55
    v_mov_b32 v55, v54
    s_nop 1
    v_permlane32_swap_b32 v54, v55
    v_mul_f32 v54, 0x3b000000, v54
    v_mul_f32 v55, 0x3b000000, v55
    v_fma_f32 v55, -v54, v54, v55
    v_max_f32 v55, 0, v55
    v_add_f32 v55, 0x3727c5ac, v55
    v_rsq_f32 v52, v55
    s_nop 0
    v_mul_f32 v53, -v54, v52
    s_mov_b32 exec_lo, 0xffff0000
    s_mov_b32 exec_hi, 0x0
    buffer_load_dword v254, v58, s[12:15], s61 offen offset:0
    s_mov_b64 exec, -1
    s_waitcnt vmcnt(6)
    s_waitcnt lgkmcnt(0)
    s_barrier
    s_cmp_ge_u32 s2, 224
    s_cselect_b32 s83, 1073741824, 0
    v_lshrrev_b32 v12, 2, v2
    v_and_b32 v13, 3, v2
    v_lshlrev_b32 v12, 7, v12
    v_lshl_add_u32 v56, v3, 10, v12
    v_lshl_add_u32 v56, v13, 3, v56
    s_lshl_b32 s78, s62, 5
    s_add_u32 s78, s78, 67584
    v_add_u32 v56, s78, v56
    ds_read_b64_tr_b16 v[168:169], v56 offset:0
    ds_read_b64_tr_b16 v[170:171], v56 offset:512
    ds_read_b64_tr_b16 v[172:173], v56 offset:4096
    ds_read_b64_tr_b16 v[174:175], v56 offset:4608
    v_lshrrev_b32 v14, 1, v3
    v_mul_u32_u24 v57, 1056, v14
    v_and_b32 v14, 1, v3
    v_lshl_add_u32 v57, v14, 9, v57
    v_add_u32 v57, v57, v12
    v_lshl_add_u32 v57, v13, 4, v57
    s_lshr_b32 s78, s62, 1
    s_lshl_b32 s78, s78, 6
    s_and_b32 s79, s62, 1
    s_lshl3_add_u32 s78, s79, s78
    s_add_u32 s78, s78, 75776
    v_add_u32 v57, s78, v57
    ds_read_b64_tr_b16 v[176:177], v57 offset:0
    ds_read_b64_tr_b16 v[178:179], v57 offset:2112
    s_lshl2_add_u32 s78, s76, s62
    s_mul_i32 s79, s78, 9363
    s_lshr_b32 s79, s79, 16
    s_mul_i32 s80, s79, 7
    s_sub_u32 s80, s78, s80
    s_lshl3_add_u32 s79, s79, s75
    s_mul_i32 s79, s79, 14336
    s_lshl_b32 s80, s80, 10
    s_add_u32 s79, s79, s80
    s_add_u32 s79, s79, 1048576
    s_add_u32 s79, s79, s83
    s_add_u32 s80, s79, 7168
    s_waitcnt lgkmcnt(2)
    buffer_store_dwordx4 v[168:171], v1, s[4:7], s79 offen sc1
    buffer_store_dwordx4 v[172:175], v1, s[4:7], s80 offen sc1
    s_and_b32 s81, s2, 7
    s_mul_i32 s81, s81, 28
    s_lshr_b32 s82, s2, 3
    s_add_u32 s81, s81, s82
    s_lshl2_add_u32 s81, s81, s62
    s_lshl_b32 s81, s81, 10
    s_add_u32 s81, s81, 3145728
    s_add_u32 s81, s81, s83
    s_waitcnt lgkmcnt(0)
    buffer_store_dwordx4 v[176:179], v1, s[4:7], s81 offen sc1
    s_mul_i32 s82, s75, 112
    s_add_u32 s82, s82, s78
    s_lshl_b32 s82, s82, 7
    s_add_u32 s82, s82, 65536
    s_add_u32 s82, s82, s83
    v_mov_b32 v12, 0
    v_mov_b32 v13, 0
    v_dot2c_f32_bf16 v12, s71, v168
    v_dot2c_f32_bf16 v12, s71, v169
    v_dot2c_f32_bf16 v12, s71, v170
    v_dot2c_f32_bf16 v12, s71, v171
    v_dot2c_f32_bf16 v12, s71, v172
    v_dot2c_f32_bf16 v12, s71, v173
    v_dot2c_f32_bf16 v12, s71, v174
    v_dot2c_f32_bf16 v12, s71, v175
    s_nop 2
    v_permlane32_swap_b32 v12, v13
    v_add_f32 v12, v12, v13
    v_mov_b32 v13, v12
    s_nop 1
    v_permlane16_swap_b32 v12, v13
    v_add_f32 v12, v12, v13
    v_mov_b32 v13, v12
    s_nop 1
    v_permlane32_swap_b32 v12, v13
    v_lshlrev_b32 v14, 2, v0
    s_mov_b32 exec_hi, 0
    buffer_store_dword v12, v14, s[4:7], s82 offen sc1
    s_mov_b64 exec, -1
    buffer_load_dword v250, off, s[24:27], 0 offset:8 sc1
    ds_read_b128 v[128:131], v7 offset:0
    ds_read_b128 v[132:135], v7 offset:8448
    ds_read_b128 v[136:139], v7 offset:16896
    ds_read_b128 v[140:143], v7 offset:25344
    s_waitcnt lgkmcnt(3)
    v_mfma_f32_16x16x32_bf16 v[16:19], v[128:131], v[64:67], 0
    s_waitcnt lgkmcnt(2)
    ds_read_b128 v[144:147], v7 offset:64
    s_mov_b32 exec_lo, 0x0
    s_mov_b32 exec_hi, 0xffffffff
    buffer_load_dword v254, v58, s[12:15], s61 offen offset:0
    s_mov_b64 exec, -1
    v_mfma_f32_16x16x32_bf16 v[20:23], v[132:135], v[64:67], 0
    s_waitcnt lgkmcnt(2)
    ds_read_b128 v[148:151], v7 offset:8512
    s_bfe_u32 s78, s74, 0x10003
    v_mfma_f32_16x16x32_bf16 v[24:27], v[136:139], v[64:67], 0
    s_waitcnt lgkmcnt(2)
    ds_read_b128 v[152:155], v7 offset:16960
    s_lshl3_add_u32 s78, s78, s70
    v_mfma_f32_16x16x32_bf16 v[28:31], v[140:143], v[64:67], 0
    s_bfe_u32 s79, s74, 0x10004
    ds_read_b128 v[156:159], v7 offset:25408
    s_lshl_b32 s79, s79, 8
    v_mfma_f32_16x16x32_bf16 v[32:35], v[128:131], v[68:71], 0
    s_add_u32 s78, s78, s79
    s_lshl4_add_u32 s78, s78, s62
    s_add_u32 s79, s62, 0
    v_mfma_f32_16x16x32_bf16 v[36:39], v[132:135], v[68:71], 0
    s_and_b32 s79, s79, 3
    s_lshl2_add_u32 s79, s79, s78
    s_lshl_b32 s48, s79, 10
    v_mfma_f32_16x16x32_bf16 v[24:27], v[136:139], v[68:71], v[24:27]
    s_add_u32 s79, s62, 1
    s_and_b32 s79, s79, 3
    s_lshl2_add_u32 s79, s79, s78
    v_mfma_f32_16x16x32_bf16 v[28:31], v[140:143], v[68:71], v[28:31]
    s_waitcnt lgkmcnt(3)
    s_lshl_b32 s49, s79, 10
    s_add_u32 s79, s62, 2
    v_mfma_f32_16x16x32_bf16 v[16:19], v[144:147], v[72:75], v[16:19]
    s_waitcnt lgkmcnt(2)
    ds_read_b128 v[128:131], v7 offset:128
    s_and_b32 s79, s79, 3
    v_mfma_f32_16x16x32_bf16 v[20:23], v[148:151], v[72:75], v[20:23]
    s_waitcnt lgkmcnt(2)
    ds_read_b128 v[132:135], v7 offset:8576
    s_lshl2_add_u32 s79, s79, s78
    v_mfma_f32_16x16x32_bf16 v[24:27], v[152:155], v[72:75], v[24:27]
    s_waitcnt lgkmcnt(2)
    ds_read_b128 v[136:139], v7 offset:17024
    s_lshl_b32 s50, s79, 10
    v_mfma_f32_16x16x32_bf16 v[28:31], v[156:159], v[72:75], v[28:31]
    s_add_u32 s79, s62, 3
    ds_read_b128 v[140:143], v7 offset:25472
    s_and_b32 s79, s79, 3
    v_mfma_f32_16x16x32_bf16 v[32:35], v[144:147], v[76:79], v[32:35]
    s_lshl2_add_u32 s79, s79, s78
    s_lshl_b32 s51, s79, 10
    s_lshl_b32 s78, s62, 4
    v_mfma_f32_16x16x32_bf16 v[36:39], v[148:151], v[76:79], v[36:39]
    v_add_u32 v8, s78, v2
    v_mul_u32_u24 v8, 144, v8
    v_mfma_f32_16x16x32_bf16 v[24:27], v[152:155], v[76:79], v[24:27]
    v_lshl_add_u32 v8, v3, 3, v8
    v_add_u32 v8, 114688, v8
    v_mfma_f32_16x16x32_bf16 v[28:31], v[156:159], v[76:79], v[28:31]
    s_waitcnt lgkmcnt(3)
    v_lshrrev_b32 v12, 2, v0
    v_mul_u32_u24 v9, 144, v12
    v_mfma_f32_16x16x32_bf16 v[16:19], v[128:131], v[80:83], v[16:19]
    s_waitcnt lgkmcnt(2)
    ds_read_b128 v[144:147], v7 offset:192
    v_and_b32 v12, 3, v0
    v_mfma_f32_16x16x32_bf16 v[20:23], v[132:135], v[80:83], v[20:23]
    s_waitcnt lgkmcnt(2)
    ds_read_b128 v[148:151], v7 offset:8640
    v_lshl_add_u32 v9, v12, 3, v9
    v_mfma_f32_16x16x32_bf16 v[24:27], v[136:139], v[80:83], v[24:27]
    s_waitcnt lgkmcnt(2)
    ds_read_b128 v[152:155], v7 offset:17088
    v_add_u32 v9, 114688, v9
    v_mfma_f32_16x16x32_bf16 v[28:31], v[140:143], v[80:83], v[28:31]
    s_lshl_b32 s78, s62, 3
    ds_read_b128 v[156:159], v7 offset:25536
    v_lshrrev_b32 v12, 1, v2
    v_mfma_f32_16x16x32_bf16 v[32:35], v[128:131], v[84:87], v[32:35]
    v_add_u32 v12, s78, v12
    v_cvt_f32_u32 v12, v12
    v_mfma_f32_16x16x32_bf16 v[36:39], v[132:135], v[84:87], v[36:39]
    v_mul_f32 v12, 0x3d000000, v12
    v_lshlrev_b32 v13, 2, v3
    v_mfma_f32_16x16x32_bf16 v[24:27], v[136:139], v[84:87], v[24:27]
    v_cvt_f32_u32 v13, v13
    v_and_b32 v14, 1, v2
    v_mfma_f32_16x16x32_bf16 v[28:31], v[140:143], v[84:87], v[28:31]
    s_waitcnt lgkmcnt(3)
    v_cvt_f32_u32 v14, v14
    v_mul_f32 v14, 0.25, v14
    v_mfma_f32_16x16x32_bf16 v[16:19], v[144:147], v[88:91], v[16:19]
    s_waitcnt lgkmcnt(2)
    ds_read_b128 v[128:131], v7 offset:256
    v_fmac_f32 v14, v13, v12
    v_mfma_f32_16x16x32_bf16 v[20:23], v[148:151], v[88:91], v[20:23]
    s_waitcnt lgkmcnt(2)
    ds_read_b128 v[132:135], v7 offset:8704
    v_fmamk_f32 v56, v12, 0x0, v14
    v_mfma_f32_16x16x32_bf16 v[24:27], v[152:155], v[88:91], v[24:27]
    s_waitcnt lgkmcnt(2)
    ds_read_b128 v[136:139], v7 offset:17152
    v_fract_f32 v56, v56
    v_mfma_f32_16x16x32_bf16 v[28:31], v[156:159], v[88:91], v[28:31]
    ds_read_b128 v[140:143], v7 offset:25600
    v_cos_f32 v58, v56
    v_mfma_f32_16x16x32_bf16 v[32:35], v[144:147], v[92:95], v[32:35]
    v_sin_f32 v60, v56
    v_fmamk_f32 v57, v12, 0x3f800000, v14
    v_mfma_f32_16x16x32_bf16 v[36:39], v[148:151], v[92:95], v[36:39]
    v_fract_f32 v57, v57
    v_cos_f32 v59, v57
    v_mfma_f32_16x16x32_bf16 v[24:27], v[152:155], v[92:95], v[24:27]
    v_sin_f32 v61, v57
    v_cvt_pk_f16_f32 v242, v58, v59
    v_mfma_f32_16x16x32_bf16 v[28:31], v[156:159], v[92:95], v[28:31]
    s_waitcnt lgkmcnt(3)
    v_cvt_pk_f16_f32 v246, v60, v61
    v_fmamk_f32 v56, v12, 0x40000000, v14
    v_mfma_f32_16x16x32_bf16 v[16:19], v[128:131], v[96:99], v[16:19]
    s_waitcnt lgkmcnt(2)
    ds_read_b128 v[144:147], v7 offset:320
    v_fract_f32 v56, v56
    v_mfma_f32_16x16x32_bf16 v[20:23], v[132:135], v[96:99], v[20:23]
    s_waitcnt lgkmcnt(2)
    ds_read_b128 v[148:151], v7 offset:8768
    v_cos_f32 v58, v56
    v_mfma_f32_16x16x32_bf16 v[24:27], v[136:139], v[96:99], v[24:27]
    s_waitcnt lgkmcnt(2)
    ds_read_b128 v[152:155], v7 offset:17216
    v_sin_f32 v60, v56
    v_mfma_f32_16x16x32_bf16 v[28:31], v[140:143], v[96:99], v[28:31]
    ds_read_b128 v[156:159], v7 offset:25664
    v_fmamk_f32 v57, v12, 0x40400000, v14
    v_mfma_f32_16x16x32_bf16 v[32:35], v[128:131], v[100:103], v[32:35]
    v_fract_f32 v57, v57
    v_cos_f32 v59, v57
    v_mfma_f32_16x16x32_bf16 v[36:39], v[132:135], v[100:103], v[36:39]
    v_sin_f32 v61, v57
    v_cvt_pk_f16_f32 v243, v58, v59
    v_mfma_f32_16x16x32_bf16 v[24:27], v[136:139], v[100:103], v[24:27]
    v_cvt_pk_f16_f32 v247, v60, v61
    v_fmamk_f32 v56, v12, 0x41800000, v14
    v_mfma_f32_16x16x32_bf16 v[28:31], v[140:143], v[100:103], v[28:31]
    s_waitcnt lgkmcnt(3)
    v_fract_f32 v56, v56
    v_cos_f32 v58, v56
    v_mfma_f32_16x16x32_bf16 v[16:19], v[144:147], v[104:107], v[16:19]
    s_waitcnt lgkmcnt(2)
    ds_read_b128 v[128:131], v7 offset:384
    v_sin_f32 v60, v56
    v_mfma_f32_16x16x32_bf16 v[20:23], v[148:151], v[104:107], v[20:23]
    s_waitcnt lgkmcnt(2)
    ds_read_b128 v[132:135], v7 offset:8832
    v_fmamk_f32 v57, v12, 0x41880000, v14
    v_mfma_f32_16x16x32_bf16 v[24:27], v[152:155], v[104:107], v[24:27]
    s_waitcnt lgkmcnt(2)
    ds_read_b128 v[136:139], v7 offset:17280
    v_fract_f32 v57, v57
    v_mfma_f32_16x16x32_bf16 v[28:31], v[156:159], v[104:107], v[28:31]
    ds_read_b128 v[140:143], v7 offset:25728
    v_cos_f32 v59, v57
    v_mfma_f32_16x16x32_bf16 v[32:35], v[144:147], v[108:111], v[32:35]
    v_sin_f32 v61, v57
    v_cvt_pk_f16_f32 v244, v58, v59
    v_mfma_f32_16x16x32_bf16 v[36:39], v[148:151], v[108:111], v[36:39]
    v_cvt_pk_f16_f32 v248, v60, v61
    v_fmamk_f32 v56, v12, 0x41900000, v14
    v_mfma_f32_16x16x32_bf16 v[24:27], v[152:155], v[108:111], v[24:27]
    v_fract_f32 v56, v56
    v_cos_f32 v58, v56
    v_mfma_f32_16x16x32_bf16 v[28:31], v[156:159], v[108:111], v[28:31]
    s_waitcnt lgkmcnt(3)
    v_sin_f32 v60, v56
    v_fmamk_f32 v57, v12, 0x41980000, v14
    v_mfma_f32_16x16x32_bf16 v[16:19], v[128:131], v[112:115], v[16:19]
    s_waitcnt lgkmcnt(2)
    ds_read_b128 v[144:147], v7 offset:448
    v_fract_f32 v57, v57
    v_mfma_f32_16x16x32_bf16 v[20:23], v[132:135], v[112:115], v[20:23]
    s_waitcnt lgkmcnt(2)
    ds_read_b128 v[148:151], v7 offset:8896
    v_cos_f32 v59, v57
    v_mfma_f32_16x16x32_bf16 v[24:27], v[136:139], v[112:115], v[24:27]
    s_waitcnt lgkmcnt(2)
    ds_read_b128 v[152:155], v7 offset:17344
    v_sin_f32 v61, v57
    v_mfma_f32_16x16x32_bf16 v[28:31], v[140:143], v[112:115], v[28:31]
    ds_read_b128 v[156:159], v7 offset:25792
    v_cvt_pk_f16_f32 v245, v58, v59
    v_mfma_f32_16x16x32_bf16 v[32:35], v[128:131], v[116:119], v[32:35]
    v_cvt_pk_f16_f32 v249, v60, v61
    v_mfma_f32_16x16x32_bf16 v[36:39], v[132:135], v[116:119], v[36:39]
    v_mfma_f32_16x16x32_bf16 v[24:27], v[136:139], v[116:119], v[24:27]
    v_mfma_f32_16x16x32_bf16 v[28:31], v[140:143], v[116:119], v[28:31]
    s_waitcnt lgkmcnt(3)
    v_mfma_f32_16x16x32_bf16 v[16:19], v[144:147], v[120:123], v[16:19]
    s_waitcnt lgkmcnt(2)
    v_mfma_f32_16x16x32_bf16 v[20:23], v[148:151], v[120:123], v[20:23]
    s_waitcnt lgkmcnt(1)
    v_mfma_f32_16x16x32_bf16 v[24:27], v[152:155], v[120:123], v[24:27]
    s_waitcnt lgkmcnt(0)
    v_mfma_f32_16x16x32_bf16 v[28:31], v[156:159], v[120:123], v[28:31]
    v_mfma_f32_16x16x32_bf16 v[32:35], v[144:147], v[124:127], v[32:35]
    v_mfma_f32_16x16x32_bf16 v[36:39], v[148:151], v[124:127], v[36:39]
    v_mfma_f32_16x16x32_bf16 v[24:27], v[152:155], v[124:127], v[24:27]
    v_mfma_f32_16x16x32_bf16 v[28:31], v[156:159], v[124:127], v[28:31]
    s_waitcnt vmcnt(8)
    s_branch L_p0e
L_iter:
    s_add_u32 s80, s45, 0
    buffer_load_dwordx4 v[64:67], v1, s[4:7], s80 offen offset:0 sc1
    s_add_u32 s79, s45, 8192
    buffer_load_dwordx4 v[68:71], v1, s[4:7], s79 offen offset:0 sc1
    buffer_load_dwordx4 v[72:75], v1, s[4:7], s80 offen offset:1024 sc1
    buffer_load_dwordx4 v[76:79], v1, s[4:7], s79 offen offset:1024 sc1
    buffer_load_dwordx4 v[80:83], v1, s[4:7], s80 offen offset:2048 sc1
    buffer_load_dwordx4 v[84:87], v1, s[4:7], s79 offen offset:2048 sc1
    buffer_load_dwordx4 v[88:91], v1, s[4:7], s80 offen offset:3072 sc1
    buffer_load_dwordx4 v[92:95], v1, s[4:7], s79 offen offset:3072 sc1
    ds_read_b128 v[128:131], v7 offset:0
    ds_read_b128 v[132:135], v7 offset:8448
    ds_read_b128 v[136:139], v7 offset:16896
    ds_read_b128 v[140:143], v7 offset:25344
    s_waitcnt vmcnt(7) lgkmcnt(3)
    v_mfma_f32_16x16x32_bf16 v[16:19], v[128:131], v[64:67], 0
    s_waitcnt lgkmcnt(2)
    ds_read_b128 v[144:147], v7 offset:64
    s_add_u32 s80, s45, 4096
    v_mfma_f32_16x16x32_bf16 v[20:23], v[132:135], v[64:67], 0
    s_waitcnt lgkmcnt(2)
    ds_read_b128 v[148:151], v7 offset:8512
    buffer_load_dwordx4 v[96:99], v1, s[4:7], s80 offen offset:0 sc1
    v_mfma_f32_16x16x32_bf16 v[24:27], v[136:139], v[64:67], 0
    s_waitcnt lgkmcnt(2)
    ds_read_b128 v[152:155], v7 offset:16960
    v_mfma_f32_16x16x32_bf16 v[28:31], v[140:143], v[64:67], 0
    s_waitcnt vmcnt(7)
    ds_read_b128 v[156:159], v7 offset:25408
    v_mfma_f32_16x16x32_bf16 v[32:35], v[128:131], v[68:71], 0
    s_add_u32 s79, s45, 12288
    buffer_load_dwordx4 v[100:103], v1, s[4:7], s79 offen offset:0 sc1
    v_mfma_f32_16x16x32_bf16 v[36:39], v[132:135], v[68:71], 0
    v_mfma_f32_16x16x32_bf16 v[24:27], v[136:139], v[68:71], v[24:27]
    v_mfma_f32_16x16x32_bf16 v[28:31], v[140:143], v[68:71], v[28:31]
    s_waitcnt vmcnt(7) lgkmcnt(3)
    v_mfma_f32_16x16x32_bf16 v[16:19], v[144:147], v[72:75], v[16:19]
    s_waitcnt lgkmcnt(2)
    ds_read_b128 v[128:131], v7 offset:128
    buffer_load_dwordx4 v[104:107], v1, s[4:7], s80 offen offset:1024 sc1
    v_mfma_f32_16x16x32_bf16 v[20:23], v[148:151], v[72:75], v[20:23]
    s_waitcnt lgkmcnt(2)
    ds_read_b128 v[132:135], v7 offset:8576
    v_add_f32 v44, v44, v46
    v_mfma_f32_16x16x32_bf16 v[24:27], v[152:155], v[72:75], v[24:27]
    s_waitcnt lgkmcnt(2)
    ds_read_b128 v[136:139], v7 offset:17024
    v_add_f32 v45, v45, v47
    v_mfma_f32_16x16x32_bf16 v[28:31], v[156:159], v[72:75], v[28:31]
    s_waitcnt vmcnt(7)
    ds_read_b128 v[140:143], v7 offset:25472
    v_add_f32 v48, v48, v50
    v_mfma_f32_16x16x32_bf16 v[32:35], v[144:147], v[76:79], v[32:35]
    buffer_load_dwordx4 v[108:111], v1, s[4:7], s79 offen offset:1024 sc1
    v_add_f32 v49, v49, v51
    v_mfma_f32_16x16x32_bf16 v[36:39], v[148:151], v[76:79], v[36:39]
    v_add_f32 v54, v44, v48
    v_mfma_f32_16x16x32_bf16 v[24:27], v[152:155], v[76:79], v[24:27]
    v_add_f32 v55, v45, v49
    v_mfma_f32_16x16x32_bf16 v[28:31], v[156:159], v[76:79], v[28:31]
    s_waitcnt vmcnt(7) lgkmcnt(3)
    v_permlane32_swap_b32 v54, v55
    v_mfma_f32_16x16x32_bf16 v[16:19], v[128:131], v[80:83], v[16:19]
    s_waitcnt lgkmcnt(2)
    ds_read_b128 v[144:147], v7 offset:192
    buffer_load_dwordx4 v[112:115], v1, s[4:7], s80 offen offset:2048 sc1
    v_mfma_f32_16x16x32_bf16 v[20:23], v[132:135], v[80:83], v[20:23]
    s_waitcnt lgkmcnt(2)
    ds_read_b128 v[148:151], v7 offset:8640
    v_add_f32 v54, v54, v55
    v_mfma_f32_16x16x32_bf16 v[24:27], v[136:139], v[80:83], v[24:27]
    s_waitcnt lgkmcnt(2)
    ds_read_b128 v[152:155], v7 offset:17088
    v_mov_b32 v55, v54
    v_mfma_f32_16x16x32_bf16 v[28:31], v[140:143], v[80:83], v[28:31]
    s_waitcnt vmcnt(7)
    ds_read_b128 v[156:159], v7 offset:25536
    v_permlane16_swap_b32 v54, v55
    v_mfma_f32_16x16x32_bf16 v[32:35], v[128:131], v[84:87], v[32:35]
    buffer_load_dwordx4 v[116:119], v1, s[4:7], s79 offen offset:2048 sc1
    v_add_f32 v54, v54, v55
    v_mfma_f32_16x16x32_bf16 v[36:39], v[132:135], v[84:87], v[36:39]
    v_mov_b32 v55, v54
    v_mfma_f32_16x16x32_bf16 v[24:27], v[136:139], v[84:87], v[24:27]
    s_nop 0
    v_permlane32_swap_b32 v54, v55
    v_mfma_f32_16x16x32_bf16 v[28:31], v[140:143], v[84:87], v[28:31]
    s_waitcnt vmcnt(7) lgkmcnt(3)
    v_mul_f32 v54, 0x3b000000, v54
    v_mfma_f32_16x16x32_bf16 v[16:19], v[144:147], v[88:91], v[16:19]
    s_waitcnt lgkmcnt(2)
    ds_read_b128 v[128:131], v7 offset:256
    buffer_load_dwordx4 v[120:123], v1, s[4:7], s80 offen offset:3072 sc1
    v_mfma_f32_16x16x32_bf16 v[20:23], v[148:151], v[88:91], v[20:23]
    s_waitcnt lgkmcnt(2)
    ds_read_b128 v[132:135], v7 offset:8704
    v_mul_f32 v55, 0x3b000000, v55
    v_mfma_f32_16x16x32_bf16 v[24:27], v[152:155], v[88:91], v[24:27]
    s_waitcnt lgkmcnt(2)
    ds_read_b128 v[136:139], v7 offset:17152
    v_fma_f32 v55, -v54, v54, v55
    v_mfma_f32_16x16x32_bf16 v[28:31], v[156:159], v[88:91], v[28:31]
    s_waitcnt vmcnt(7)
    ds_read_b128 v[140:143], v7 offset:25600
    v_max_f32 v55, 0, v55
    v_mfma_f32_16x16x32_bf16 v[32:35], v[144:147], v[92:95], v[32:35]
    buffer_load_dwordx4 v[124:127], v1, s[4:7], s79 offen offset:3072 sc1
    v_add_f32 v55, 0x3727c5ac, v55
    v_mfma_f32_16x16x32_bf16 v[36:39], v[148:151], v[92:95], v[36:39]
    v_rsq_f32 v52, v55
    v_mfma_f32_16x16x32_bf16 v[24:27], v[152:155], v[92:95], v[24:27]
    v_mul_f32 v53, -v54, v52
    v_mfma_f32_16x16x32_bf16 v[28:31], v[156:159], v[92:95], v[28:31]
    s_waitcnt vmcnt(7) lgkmcnt(3)
    v_mfma_f32_16x16x32_bf16 v[16:19], v[128:131], v[96:99], v[16:19]
    s_waitcnt lgkmcnt(2)
    ds_read_b128 v[144:147], v7 offset:320
    s_add_u32 s85, s88, 0xe0000
    v_mfma_f32_16x16x32_bf16 v[20:23], v[132:135], v[96:99], v[20:23]
    s_waitcnt lgkmcnt(2)
    ds_read_b128 v[148:151], v7 offset:8768
    s_add_u32 m0, s69, 0x0
    v_mfma_f32_16x16x32_bf16 v[24:27], v[136:139], v[96:99], v[24:27]
    s_waitcnt lgkmcnt(2)
    ds_read_b128 v[152:155], v7 offset:17216
    buffer_load_dwordx4 v1, s[4:7], s85 offen offset:0 sc1 lds
    v_mfma_f32_16x16x32_bf16 v[28:31], v[140:143], v[96:99], v[28:31]
    s_waitcnt vmcnt(7)
    ds_read_b128 v[156:159], v7 offset:25664
    v_mfma_f32_16x16x32_bf16 v[32:35], v[128:131], v[100:103], v[32:35]
    buffer_load_dwordx4 v1, s[4:7], s85 offen offset:1024 sc1 lds
    v_mfma_f32_16x16x32_bf16 v[36:39], v[132:135], v[100:103], v[36:39]
    v_mfma_f32_16x16x32_bf16 v[24:27], v[136:139], v[100:103], v[24:27]
    v_mfma_f32_16x16x32_bf16 v[28:31], v[140:143], v[100:103], v[28:31]
    s_waitcnt vmcnt(7) lgkmcnt(3)
    v_mfma_f32_16x16x32_bf16 v[16:19], v[144:147], v[104:107], v[16:19]
    s_waitcnt lgkmcnt(2)
    ds_read_b128 v[128:131], v7 offset:384
    buffer_load_dwordx4 v1, s[4:7], s85 offen offset:2048 sc1 lds
    v_mfma_f32_16x16x32_bf16 v[20:23], v[148:151], v[104:107], v[20:23]
    s_waitcnt lgkmcnt(2)
    ds_read_b128 v[132:135], v7 offset:8832
    v_mfma_f32_16x16x32_bf16 v[24:27], v[152:155], v[104:107], v[24:27]
    s_waitcnt lgkmcnt(2)
    ds_read_b128 v[136:139], v7 offset:17280
    v_mfma_f32_16x16x32_bf16 v[28:31], v[156:159], v[104:107], v[28:31]
    s_waitcnt vmcnt(7)
    ds_read_b128 v[140:143], v7 offset:25728
    v_mfma_f32_16x16x32_bf16 v[32:35], v[144:147], v[108:111], v[32:35]
    buffer_load_dwordx4 v1, s[4:7], s85 offen offset:3072 sc1 lds
    v_mfma_f32_16x16x32_bf16 v[36:39], v[148:151], v[108:111], v[36:39]
    v_mfma_f32_16x16x32_bf16 v[24:27], v[152:155], v[108:111], v[24:27]
    v_mfma_f32_16x16x32_bf16 v[28:31], v[156:159], v[108:111], v[28:31]
    s_waitcnt vmcnt(7) lgkmcnt(3)
    v_mfma_f32_16x16x32_bf16 v[16:19], v[128:131], v[112:115], v[16:19]
    s_waitcnt lgkmcnt(2)
    ds_read_b128 v[144:147], v7 offset:448
    s_add_u32 s85, s88, 0xe1000
    v_mfma_f32_16x16x32_bf16 v[20:23], v[132:135], v[112:115], v[20:23]
    s_waitcnt lgkmcnt(2)
    ds_read_b128 v[148:151], v7 offset:8896
    s_add_u32 m0, s69, 0x1000
    v_mfma_f32_16x16x32_bf16 v[24:27], v[136:139], v[112:115], v[24:27]
    s_waitcnt lgkmcnt(2)
    ds_read_b128 v[152:155], v7 offset:17344
    buffer_load_dwordx4 v1, s[4:7], s85 offen offset:0 sc1 lds
    v_mfma_f32_16x16x32_bf16 v[28:31], v[140:143], v[112:115], v[28:31]
    s_waitcnt vmcnt(7)
    ds_read_b128 v[156:159], v7 offset:25792
    v_mfma_f32_16x16x32_bf16 v[32:35], v[128:131], v[116:119], v[32:35]
    buffer_load_dwordx4 v1, s[4:7], s85 offen offset:1024 sc1 lds
    v_mfma_f32_16x16x32_bf16 v[36:39], v[132:135], v[116:119], v[36:39]
    v_mfma_f32_16x16x32_bf16 v[24:27], v[136:139], v[116:119], v[24:27]
    v_mfma_f32_16x16x32_bf16 v[28:31], v[140:143], v[116:119], v[28:31]
    s_waitcnt vmcnt(7) lgkmcnt(3)
    v_mfma_f32_16x16x32_bf16 v[16:19], v[144:147], v[120:123], v[16:19]
    s_waitcnt lgkmcnt(2)
    v_mfma_f32_16x16x32_bf16 v[20:23], v[148:151], v[120:123], v[20:23]
    s_waitcnt lgkmcnt(1)
    v_mfma_f32_16x16x32_bf16 v[24:27], v[152:155], v[120:123], v[24:27]
    s_waitcnt lgkmcnt(0)
    v_mfma_f32_16x16x32_bf16 v[28:31], v[156:159], v[120:123], v[28:31]
    s_waitcnt vmcnt(6)
    v_mfma_f32_16x16x32_bf16 v[32:35], v[144:147], v[124:127], v[32:35]
    v_mfma_f32_16x16x32_bf16 v[36:39], v[148:151], v[124:127], v[36:39]
    v_mfma_f32_16x16x32_bf16 v[24:27], v[152:155], v[124:127], v[24:27]
    v_mfma_f32_16x16x32_bf16 v[28:31], v[156:159], v[124:127], v[28:31]
L_p0e:
    s_nop 5
    v_pk_add_f32 v[16:17], v[16:17], v[32:33] neg_lo:[0,1] neg_hi:[0,1]
    v_pk_mul_f32 v[16:17], v[16:17], v[52:53] op_sel_hi:[1,0]
    v_pk_add_f32 v[18:19], v[18:19], v[34:35] neg_lo:[0,1] neg_hi:[0,1]
    v_pk_mul_f32 v[18:19], v[18:19], v[52:53] op_sel_hi:[1,0]
    v_cvt_pk_f16_f32 v160, v16, v17
    v_cvt_pk_f16_f32 v161, v18, v19
    ds_write_b64 v8, v[160:161] offset:0
    v_pk_add_f32 v[20:21], v[20:21], v[36:37] neg_lo:[0,1] neg_hi:[0,1]
    v_pk_mul_f32 v[20:21], v[20:21], v[52:53] op_sel_hi:[1,0]
    v_pk_add_f32 v[22:23], v[22:23], v[38:39] neg_lo:[0,1] neg_hi:[0,1]
    v_pk_mul_f32 v[22:23], v[22:23], v[52:53] op_sel_hi:[1,0]
    v_cvt_pk_f16_f32 v162, v20, v21
    v_cvt_pk_f16_f32 v163, v22, v23
    ds_write_b64 v8, v[162:163] offset:32
    v_pk_mul_f32 v[24:25], v[24:25], v[52:53] op_sel_hi:[1,0]
    v_pk_mul_f32 v[26:27], v[26:27], v[52:53] op_sel_hi:[1,0]
    v_cvt_pk_f16_f32 v164, v24, v25
    v_cvt_pk_f16_f32 v165, v26, v27
    ds_write_b64 v8, v[164:165] offset:64
    v_pk_mul_f32 v[28:29], v[28:29], v[52:53] op_sel_hi:[1,0]
    v_pk_mul_f32 v[30:31], v[30:31], v[52:53] op_sel_hi:[1,0]
    v_cvt_pk_f16_f32 v166, v28, v29
    v_cvt_pk_f16_f32 v167, v30, v31
    ds_write_b64 v8, v[166:167] offset:96
    s_add_u32 s85, s28, 0x10000
    s_waitcnt lgkmcnt(0)
    s_barrier
    ds_read_b64_tr_b16 v[128:129], v9 offset:0
    ds_read_b64_tr_b16 v[130:131], v9 offset:4608
    ds_read_b64_tr_b16 v[132:133], v9 offset:32
    ds_read_b64_tr_b16 v[134:135], v9 offset:4640
    ds_read_b64_tr_b16 v[136:137], v9 offset:2304
    ds_read_b64_tr_b16 v[138:139], v9 offset:6912
    ds_read_b64_tr_b16 v[140:141], v9 offset:2336
    ds_read_b64_tr_b16 v[142:143], v9 offset:6944
    ds_read_b64_tr_b16 v[144:145], v9 offset:64
    ds_read_b64_tr_b16 v[146:147], v9 offset:4672
    ds_read_b64_tr_b16 v[148:149], v9 offset:96
    ds_read_b64_tr_b16 v[150:151], v9 offset:4704
    ds_read_b64_tr_b16 v[152:153], v9 offset:2368
    ds_read_b64_tr_b16 v[154:155], v9 offset:6976
    ds_read_b64_tr_b16 v[156:157], v9 offset:2400
    ds_read_b64_tr_b16 v[158:159], v9 offset:7008
    s_waitcnt lgkmcnt(12)
    v_mfma_f32_16x16x32_f16 v[16:19], v[242:245], v[128:131], 0
    v_mfma_f32_16x16x32_f16 v[16:19], v[246:249], v[132:135], v[16:19]
    s_waitcnt lgkmcnt(8)
    v_mfma_f32_16x16x32_f16 v[20:23], v[242:245], v[136:139], 0
    v_mfma_f32_16x16x32_f16 v[20:23], v[246:249], v[140:143], v[20:23]
    s_waitcnt lgkmcnt(4)
    v_mfma_f32_16x16x32_f16 v[24:27], v[242:245], v[144:147], 0
    v_mfma_f32_16x16x32_f16 v[24:27], v[246:249], v[148:151], v[24:27]
    s_waitcnt lgkmcnt(0)
    v_mfma_f32_16x16x32_f16 v[28:31], v[242:245], v[152:155], 0
    v_mfma_f32_16x16x32_f16 v[28:31], v[246:249], v[156:159], v[28:31]
    v_cvt_pk_f16_f32 v160, v16, v17
    v_cvt_pk_f16_f32 v164, v18, v19
    v_cvt_pk_f16_f32 v161, v20, v21
    v_cvt_pk_f16_f32 v165, v22, v23
    s_nop 0
    v_cvt_pk_f16_f32 v162, v24, v25
    v_cvt_pk_f16_f32 v166, v26, v27
    s_nop 0
    v_cvt_pk_f16_f32 v163, v28, v29
    v_cvt_pk_f16_f32 v167, v30, v31
    buffer_store_dwordx4 v[160:163], v10, s[4:7], s28 offen sc1
    buffer_store_dwordx4 v[164:167], v10, s[4:7], s85 offen sc1
    s_cmp_lg_u32 s66, 0
    s_cbranch_scc1 L_p1b_3
    s_lshl2_add_u32 s85, s2, s62
    s_lshl_b32 s85, s85, 11
    s_add_u32 s85, s85, 16777216
    buffer_store_dwordx4 v[188:191], v1, s[4:7], s85 offen sc1
    buffer_store_dwordx4 v[188:191], v1, s[4:7], s85 offen offset:1024 sc1
    v_mul_u32_u24 v56, 1040, v2
    v_lshl_add_u32 v56, v3, 8, v56
    v_add_u32 v56, s72, v56
    v_add_u32 v57, 67584, v56
    s_waitcnt vmcnt(5)
    v_cmp_gt_u32 vcc, 1, v250
    s_cbranch_vccnz L_rt_5
L_bk_6:
    s_barrier
    s_add_u32 s75, s66, s62
    s_cmp_lg_u32 s75, 0
    s_cbranch_scc1 L_skip_7
    v_lshlrev_b32 v12, 10, v0
    s_lshl_b32 s75, 1, s74
    v_mov_b32 v250, s75
    v_mov_b32 v251, 0x100
    s_lshl_b32 s75, s70, 7
    s_mov_b64 exec, 0xff
    buffer_atomic_add_x2 v[250:251], v12, s[4:7], s75 offen sc1
    s_mov_b64 exec, -1
L_skip_7:
L_stage:
    s_add_u32 s85, s48, 0
    s_add_u32 m0, s72, 0
    s_nop 0
    buffer_load_dwordx4 v1, s[12:15], s85 offen lds
    v_add_u32 v5, 57344, v1
    v_add_u32 v6, 114688, v1
    v_lshrrev_b32 v13, 1, v3
    v_lshlrev_b32 v13, 2, v13
    v_lshl_add_u32 v231, v2, 4, v13
    v_and_b32 v13, 1, v3
    v_lshl_add_u32 v229, v13, 11, v231
    v_lshl_add_u32 v239, v13, 3, v231
    v_and_b32 v230, 7, v0
    v_lshlrev_b32 v230, 8, v230
    v_lshlrev_b32 v241, 16, v2
    s_add_u32 s85, s48, 262144
    s_add_u32 m0, s72, 1040
    s_nop 0
    buffer_load_dwordx4 v1, s[12:15], s85 offen lds
    v_lshl_add_u32 v241, v3, 4, v241
    s_mul_i32 s78, s62, 3904
    s_add_u32 s78, s78, 143360
    v_mul_u32_u24 v232, 240, v2
    v_lshl_add_u32 v232, v3, 3, v232
    v_add_u32 v232, s78, v232
    s_and_b32 s78, s62, 1
    s_mul_i32 s78, s78, 1920
    s_lshr_b32 s79, s62, 1
    s_lshl_b32 s79, s79, 7
    s_add_u32 s78, s78, s79
    s_add_u32 s85, s48, 524288
    s_add_u32 m0, s72, 2080
    s_nop 0
    buffer_load_dwordx4 v1, s[12:15], s85 offen lds
    s_add_u32 s78, s78, 143360
    v_and_b32 v12, 3, v0
    v_lshrrev_b32 v13, 2, v2
    v_mul_u32_u24 v233, 3904, v13
    v_lshl_add_u32 v233, v12, 3, v233
    v_mul_u32_u24 v13, 480, v3
    v_add3_u32 v233, v233, v13, s78
    v_lshlrev_b32 v234, 4, v3
    v_add_u32 v234, 158976, v234
    s_add_u32 s78, s62, 0
    s_and_b32 s78, s78, 3
    s_add_u32 s85, s48, 786432
    s_add_u32 m0, s72, 3120
    s_nop 0
    buffer_load_dwordx4 v1, s[12:15], s85 offen lds
    s_mul_i32 s78, s78, 3072
    s_add_u32 s78, s78, 114688
    v_add_u32 v238, s78, v1
    s_add_u32 s78, s62, 1
    s_and_b32 s78, s78, 3
    s_mul_i32 s78, s78, 3072
    s_add_u32 s78, s78, 114688
    v_add_u32 v235, s78, v1
    s_add_u32 s78, s62, 2
    s_and_b32 s78, s78, 3
    s_mul_i32 s78, s78, 3072
    s_add_u32 s85, s48, 1048576
    s_add_u32 m0, s72, 4160
    s_nop 0
    buffer_load_dwordx4 v1, s[12:15], s85 offen lds
    s_add_u32 s78, s78, 115712
    v_add_u32 v236, s78, v1
    s_add_u32 s78, s62, 3
    s_and_b32 s78, s78, 3
    s_mul_i32 s78, s78, 3072
    s_add_u32 s78, s78, 116736
    v_add_u32 v237, s78, v1
    s_mov_b32 s63, s70
    s_lshr_b32 s64, s74, 3
    s_and_b32 s65, s74, 7
    s_and_b32 s80, s62, 2
    s_add_u32 s85, s48, 1310720
    s_add_u32 m0, s72, 5200
    s_nop 0
    buffer_load_dwordx4 v1, s[12:15], s85 offen lds
    s_and_b32 s81, s62, 1
    s_lshl1_add_u32 s81, s65, s81
    s_lshl2_add_u32 s82, s63, s64
    s_lshl2_add_u32 s82, s82, s80
    s_lshl_b32 s35, s82, 7
    s_add_u32 s35, s35, s81
    s_add_u32 s35, s35, 32768
    s_lshl2_add_u32 s83, s63, s62
    s_lshl2_add_u32 s83, s83, s64
    s_lshl_b32 s91, s83, 7
    s_add_u32 s91, s91, 32768
    s_add_u32 s85, s48, 1572864
    s_add_u32 m0, s72, 6240
    s_nop 0
    buffer_load_dwordx4 v1, s[12:15], s85 offen lds
    s_lshl1_add_u32 s43, s65, s91
    s_lshl_b32 s34, s83, 10
    s_add_u32 s34, s34, 524288
    s_lshr_b32 s78, s65, 1
    s_lshl_b32 s78, s78, 5
    s_and_b32 s79, s65, 1
    s_add_u32 s78, s78, s79
    s_lshl_b32 s78, s78, 3
    v_add_u32 v231, s78, v231
    s_and_b32 s80, s62, 2
    s_and_b32 s81, s62, 1
    s_add_u32 s85, s48, 1835008
    s_add_u32 m0, s72, 7280
    s_nop 0
    buffer_load_dwordx4 v1, s[12:15], s85 offen lds
    s_lshl1_add_u32 s81, s65, s81
    s_lshl2_add_u32 s82, s63, s64
    s_lshl2_add_u32 s82, s82, s80
    s_lshl4_add_u32 s29, s82, s81
    s_lshl_b32 s29, s29, 10
    s_add_u32 s29, s29, 4194304
    s_add_u32 s30, s29, 0x4000
    s_lshl_b32 s31, s82, 8
    s_lshl_b32 s78, s65, 5
    s_add_u32 s31, s31, s78
    s_and_b32 s78, s62, 1
    s_add_u32 s85, s48, 2097152
    s_add_u32 m0, s72, 8320
    s_nop 0
    buffer_load_dwordx4 v1, s[12:15], s85 offen lds
    s_add_u32 s31, s31, s78
    s_lshl_b32 s31, s31, 3
    s_add_u32 s31, s31, 262144
    s_lshl2_add_u32 s78, s63, s64
    s_lshl_b32 s33, s78, 11
    s_add_u32 s33, s33, 10485760
    s_lshr_b32 s79, s65, 2
    s_sub_u32 s79, 0, s79
    s_xor_b32 s78, s78, s79
    s_sub_u32 s78, s78, s79
    s_and_b32 s78, s78, 31
    s_add_u32 s85, s48, 2359296
    s_add_u32 m0, s72, 9360
    s_nop 0
    buffer_load_dwordx4 v1, s[12:15], s85 offen lds
    s_lshl_b32 s78, s78, 16
    s_and_b32 s83, s79, 15
    s_xor_b32 s84, s81, s83
    s_lshl_b32 s84, s84, 8
    s_add_u32 s78, s78, s84
    s_and_b32 s84, s79, 8
    s_add_u32 s78, s78, s84
    s_add_u32 s32, s78, 10485752
    v_xor_b32 v228, s83, v2
    v_lshlrev_b32 v228, 4, v228
    v_lshl_add_u32 v228, v3, 12, v228
    s_add_u32 s85, s48, 2621440
    s_add_u32 m0, s72, 10400
    s_nop 0
    buffer_load_dwordx4 v1, s[12:15], s85 offen lds
    s_min_u32 s78, s81, 1
    s_sub_u32 s78, s78, 1
    s_and_b32 s86, s78, 0xffff
    s_mov_b32 s87, 0
    s_mul_i32 s78, s65, 114688
    s_add_u32 s78, s78, s69
    s_add_u32 s88, s78, 1048576
    s_add_u32 s95, s78, 3145728
    s_lshl2_add_u32 s83, s63, s62
    s_lshl2_add_u32 s83, s83, s64
    s_lshl_b32 s89, s83, 14
    s_add_u32 s85, s48, 2883584
    s_add_u32 m0, s72, 11440
    s_nop 0
    buffer_load_dwordx4 v1, s[12:15], s85 offen lds
    s_add_u32 s89, s89, 4194304
    s_lshl_b32 s90, s83, 11
    s_add_u32 s90, s90, 262144
    s_lshl_b32 s78, s65, 11
    s_add_u32 s41, s89, s78
    s_lshl_b32 s78, s65, 8
    s_add_u32 s42, s90, s78
    s_lshl_b32 s79, s83, 14
    s_add_u32 s37, s79, 4194304
    s_lshl_b32 s78, s65, 10
    s_add_u32 s38, s37, s78
    s_add_u32 s85, s48, 3145728
    s_add_u32 m0, s72, 12480
    s_nop 0
    buffer_load_dwordx4 v1, s[12:15], s85 offen lds
    s_add_u32 s40, s79, 10485760
    s_add_u32 s76, s40, s78
    s_lshr_b32 s78, s65, 1
    s_lshl_b32 s78, s78, 7
    s_and_b32 s79, s65, 1
    s_add_u32 s78, s78, s79
    s_lshl3_add_u32 s39, s78, s40
    s_add_u32 s39, s39, 8192
    s_and_b32 s78, s64, 2
    s_lshl2_add_u32 s78, s65, s78
    s_and_b32 s79, s62, 1
    s_add_u32 s85, s48, 3407872
    s_add_u32 m0, s72, 13520
    s_nop 0
    buffer_load_dwordx4 v1, s[12:15], s85 offen lds
    s_add_u32 s78, s78, s79
    s_and_b32 s80, s64, 1
    s_lshl1_add_u32 s80, s63, s80
    s_lshr_b32 s79, s62, 1
    s_lshl_b32 s93, s78, 5
    s_add_u32 s93, s93, s80
    s_lshl1_add_u32 s93, s93, s79
    s_lshl_b32 s93, s93, 1
    s_add_u32 s93, s93, 16384
    s_mul_i32 s78, s78, 7
    s_lshl2_add_u32 s78, s79, s78
    s_add_u32 s85, s48, 3670016
    s_add_u32 m0, s72, 14560
    s_nop 0
    buffer_load_dwordx4 v1, s[12:15], s85 offen lds
    s_lshl4_add_u32 s78, s78, s80
    s_lshl_b32 s78, s78, 10
    s_add_u32 s92, s78, 12582912
    s_lshl2_add_u32 s78, s65, s62
    s_lshl_b32 s94, s78, 7
    s_add_u32 s94, s94, 16384
    s_mul_i32 s78, s78, 114688
    s_add_u32 s36, s78, 12582912
    s_lshl2_add_u32 s78, s63, s62
    s_and_b32 s79, s64, 1
    s_lshl_b32 s79, s79, 5
    s_add_u32 s85, s48, 3932160
    s_add_u32 m0, s72, 15600
    s_nop 0
    buffer_load_dwordx4 v1, s[12:15], s85 offen lds
    s_add_u32 s78, s78, s79
    s_lshr_b32 s79, s64, 1
    s_lshl_b32 s79, s79, 10
    s_add_u32 s78, s78, s79
    s_lshl3_add_u32 s78, s78, s65
    s_lshl_b32 s44, s78, 7
    s_lshl2_add_u32 s83, s63, s64
    s_lshl2_add_u32 s83, s83, s62
    s_lshl_b32 s45, s83, 14
    s_add_u32 s45, s45, 4194304
    s_lshl_b32 s46, s83, 11
    s_add_u32 s85, s49, 0
    s_add_u32 m0, s72, 67584
    s_nop 0
    buffer_load_dwordx4 v1, s[12:15], s85 offen lds
    s_add_u32 s46, s46, 262144
    s_lshl_b32 s47, s83, 7
    s_add_u32 s47, s47, 32768
    s_lshl2_add_u32 s79, s74, s62
    s_mul_i32 s79, s79, 384
    v_min_u32 v240, 2, v0
    v_lshlrev_b32 v240, 7, v240
    v_add_u32 v240, s79, v240
    v_min_u32 v240, L_last-interleave_layers__spectral_fnet__mixer_gmlp__prompt_kernel-64, v240
    s_lshl2_add_u32 s79, s63, s64
    s_lshl3_add_u32 s79, s79, s65
    s_add_u32 s85, s49, 262144
    s_add_u32 m0, s72, 68624
    s_nop 0
    buffer_load_dwordx4 v1, s[12:15], s85 offen lds
    s_lshl_b32 s79, s79, 8
    s_lshl_b32 s28, s62, 19
    s_add_u32 s28, s28, s79
    s_add_u32 s28, s28, 10485760
    s_lshr_b32 s78, s62, 1
    s_lshl2_add_u32 s73, s65, s78
    s_lshl_b32 s73, s73, 13
    s_mov_b32 s54, 0
    s_mov_b32 s55, 1
    s_and_b32 s80, s62, 2
    s_and_b32 s81, s62, 1
    s_add_u32 s85, s49, 524288
    s_add_u32 m0, s72, 69664
    s_nop 0
    buffer_load_dwordx4 v1, s[12:15], s85 offen lds
    s_lshl1_add_u32 s81, s65, s81
    s_lshl2_add_u32 s78, s63, s64
    s_and_b32 s79, s80, 1
    s_lshl_b32 s79, s79, 5
    s_add_u32 s78, s78, s79
    s_lshr_b32 s79, s80, 1
    s_lshl_b32 s79, s79, 10
    s_add_u32 s78, s78, s79
    s_lshl4_add_u32 s78, s78, s81
    s_lshl_b32 s78, s78, 6
    s_add_u32 s79, s78, 0x8000
    s_add_u32 s85, s49, 786432
    s_add_u32 m0, s72, 70704
    s_nop 0
    buffer_load_dwordx4 v1, s[12:15], s85 offen lds
    buffer_load_dwordx4 v[44:47], v241, s[16:19], s78 offen
    buffer_load_dwordx4 v[48:51], v241, s[16:19], s79 offen
    v_lshrrev_b32 v59, 1, v230
    s_lshl_b32 s75, s70, 10
    s_and_b32 s82, s62, 2
    s_lshl2_add_u32 s83, s63, s64
    s_and_b32 s84, s82, 1
    s_lshl_b32 s84, s84, 5
    s_add_u32 s83, s83, s84
    s_lshr_b32 s84, s82, 1
    s_lshl_b32 s84, s84, 10
    s_add_u32 s85, s49, 1048576
    s_add_u32 m0, s72, 71744
    s_nop 0
    buffer_load_dwordx4 v1, s[12:15], s85 offen lds
    s_add_u32 s83, s83, s84
    s_and_b32 s84, s65, 4
    s_lshl_b32 s84, s84, 29
    s_or_b32 s84, s84, 0x3a000000
    v_lshl_add_u32 v12, v2, 6, s83
    v_add_u32 v13, 32, v12
    v_cvt_f32_u32 v12, v12
    v_cvt_f32_u32 v13, v13
    v_mul_f32 v12, s84, v12
    v_mul_f32 v13, s84, v13
    v_lshlrev_b32 v15, 1, v3
    s_add_u32 s85, s49, 1310720
    s_add_u32 m0, s72, 72784
    s_nop 0
    buffer_load_dwordx4 v1, s[12:15], s85 offen lds
    v_cvt_f32_u32 v15, v15
    v_mul_f32 v14, v15, v12
    v_mul_f32 v15, v15, v13
    s_waitcnt vmcnt(8)
    ds_read_b64 a[0:1], v56 offset:0
    ds_read_b64 a[2:3], v56 offset:128
    v_fmamk_f32 v60, v12, 0x0, v14
    v_fmamk_f32 v61, v13, 0x0, v15
    v_fract_f32 v60, v60
    v_fract_f32 v61, v61
    v_cos_f32 v62, v60
    v_sin_f32 v60, v60
    s_add_u32 s85, s49, 1572864
    s_add_u32 m0, s72, 73824
    s_nop 0
    buffer_load_dwordx4 v1, s[12:15], s85 offen lds
    ds_read_b64 a[16:17], v56 offset:64
    ds_read_b64 a[18:19], v56 offset:192
    v_cos_f32 v63, v61
    v_sin_f32 v61, v61
    v_cvt_pk_f16_f32 v196, v62, v60
    v_cvt_pk_f16_f32 v212, v63, v61
    s_add_u32 s85, s49, 1835008
    s_add_u32 m0, s72, 74864
    s_nop 0
    buffer_load_dwordx4 v1, s[12:15], s85 offen lds
    ds_read_b64 a[32:33], v56 offset:8
    ds_read_b64 a[34:35], v56 offset:136
    v_fmamk_f32 v60, v12, 0x42000000, v14
    v_fmamk_f32 v61, v13, 0x42000000, v15
    v_fract_f32 v60, v60
    v_fract_f32 v61, v61
    v_cos_f32 v62, v60
    v_sin_f32 v60, v60
    s_add_u32 s85, s49, 2097152
    s_add_u32 m0, s72, 75904
    s_nop 0
    buffer_load_dwordx4 v1, s[12:15], s85 offen lds
    ds_read_b64 a[48:49], v56 offset:72
    ds_read_b64 a[50:51], v56 offset:200
    v_cos_f32 v63, v61
    v_sin_f32 v61, v61
    v_cvt_pk_f16_f32 v197, v62, v60
    v_cvt_pk_f16_f32 v213, v63, v61
    s_add_u32 s85, s49, 2359296
    s_add_u32 m0, s72, 76944
    s_nop 0
    buffer_load_dwordx4 v1, s[12:15], s85 offen lds
    ds_read_b64 a[64:65], v56 offset:16
    ds_read_b64 a[66:67], v56 offset:144
    v_fmamk_f32 v60, v12, 0x3f800000, v14
    v_fmamk_f32 v61, v13, 0x3f800000, v15
    v_fract_f32 v60, v60
    v_fract_f32 v61, v61
    v_cos_f32 v62, v60
    v_sin_f32 v60, v60
    s_add_u32 s85, s49, 2621440
    s_add_u32 m0, s72, 77984
    s_nop 0
    buffer_load_dwordx4 v1, s[12:15], s85 offen lds
    ds_read_b64 a[80:81], v56 offset:80
    ds_read_b64 a[82:83], v56 offset:208
    v_cos_f32 v63, v61
    v_sin_f32 v61, v61
    v_cvt_pk_f16_f32 v198, v62, v60
    v_cvt_pk_f16_f32 v214, v63, v61
    s_add_u32 s85, s49, 2883584
    s_add_u32 m0, s72, 79024
    s_nop 0
    buffer_load_dwordx4 v1, s[12:15], s85 offen lds
    ds_read_b64 a[96:97], v56 offset:24
    ds_read_b64 a[98:99], v56 offset:152
    v_fmamk_f32 v60, v12, 0x42040000, v14
    v_fmamk_f32 v61, v13, 0x42040000, v15
    v_fract_f32 v60, v60
    v_fract_f32 v61, v61
    v_cos_f32 v62, v60
    v_sin_f32 v60, v60
    s_add_u32 s85, s49, 3145728
    s_add_u32 m0, s72, 80064
    s_nop 0
    buffer_load_dwordx4 v1, s[12:15], s85 offen lds
    ds_read_b64 a[112:113], v56 offset:88
    ds_read_b64 a[114:115], v56 offset:216
    v_cos_f32 v63, v61
    v_sin_f32 v61, v61
    v_cvt_pk_f16_f32 v199, v62, v60
    v_cvt_pk_f16_f32 v215, v63, v61
    s_add_u32 s85, s49, 3407872
    s_add_u32 m0, s72, 81104
    s_nop 0
    buffer_load_dwordx4 v1, s[12:15], s85 offen lds
    ds_read_b64 a[128:129], v56 offset:32
    ds_read_b64 a[130:131], v56 offset:160
    v_fmamk_f32 v60, v12, 0x41000000, v14
    v_fmamk_f32 v61, v13, 0x41000000, v15
    v_fract_f32 v60, v60
    v_fract_f32 v61, v61
    v_cos_f32 v62, v60
    v_sin_f32 v60, v60
    s_add_u32 s85, s49, 3670016
    s_add_u32 m0, s72, 82144
    s_nop 0
    buffer_load_dwordx4 v1, s[12:15], s85 offen lds
    ds_read_b64 a[144:145], v56 offset:96
    ds_read_b64 a[146:147], v56 offset:224
    v_cos_f32 v63, v61
    v_sin_f32 v61, v61
    v_cvt_pk_f16_f32 v200, v62, v60
    v_cvt_pk_f16_f32 v216, v63, v61
    s_add_u32 s85, s49, 3932160
    s_add_u32 m0, s72, 83184
    s_nop 0
    buffer_load_dwordx4 v1, s[12:15], s85 offen lds
    ds_read_b64 a[160:161], v56 offset:40
    ds_read_b64 a[162:163], v56 offset:168
    v_fmamk_f32 v60, v12, 0x42200000, v14
    v_fmamk_f32 v61, v13, 0x42200000, v15
    v_fract_f32 v60, v60
    v_fract_f32 v61, v61
    v_cos_f32 v62, v60
    v_sin_f32 v60, v60
    ds_read_b64 a[176:177], v56 offset:104
    ds_read_b64 a[178:179], v56 offset:232
    v_cos_f32 v63, v61
    v_sin_f32 v61, v61
    v_cvt_pk_f16_f32 v201, v62, v60
    v_cvt_pk_f16_f32 v217, v63, v61
    ds_read_b64 a[192:193], v56 offset:48
    ds_read_b64 a[194:195], v56 offset:176
    v_fmamk_f32 v60, v12, 0x41100000, v14
    v_fmamk_f32 v61, v13, 0x41100000, v15
    v_fract_f32 v60, v60
    v_fract_f32 v61, v61
    v_cos_f32 v62, v60
    v_sin_f32 v60, v60
    ds_read_b64 a[208:209], v56 offset:112
    ds_read_b64 a[210:211], v56 offset:240
    v_cos_f32 v63, v61
    v_sin_f32 v61, v61
    v_cvt_pk_f16_f32 v202, v62, v60
    v_cvt_pk_f16_f32 v218, v63, v61
    ds_read_b64 a[224:225], v56 offset:56
    ds_read_b64 a[226:227], v56 offset:184
    v_fmamk_f32 v60, v12, 0x42240000, v14
    v_fmamk_f32 v61, v13, 0x42240000, v15
    v_fract_f32 v60, v60
    v_fract_f32 v61, v61
    v_cos_f32 v62, v60
    v_sin_f32 v60, v60
    ds_read_b64 a[240:241], v56 offset:120
    ds_read_b64 a[242:243], v56 offset:248
    v_cos_f32 v63, v61
    v_sin_f32 v61, v61
    v_cvt_pk_f16_f32 v203, v62, v60
    v_cvt_pk_f16_f32 v219, v63, v61
    s_waitcnt lgkmcnt(0)
    buffer_load_dwordx2 v[250:251], v59, s[4:7], s75 offen sc1
    v_fmamk_f32 v60, v12, 0x41800000, v14
    v_fmamk_f32 v61, v13, 0x41800000, v15
    v_fract_f32 v60, v60
    v_fract_f32 v61, v61
    v_cos_f32 v62, v60
    v_sin_f32 v60, v60
    s_add_u32 s85, s50, 0
    s_add_u32 m0, s72, 0
    s_nop 0
    buffer_load_dwordx4 v1, s[12:15], s85 offen lds
    v_cos_f32 v63, v61
    v_sin_f32 v61, v61
    v_cvt_pk_f16_f32 v204, v62, v60
    v_cvt_pk_f16_f32 v220, v63, v61
    s_add_u32 s85, s50, 262144
    s_add_u32 m0, s72, 1040
    s_nop 0
    buffer_load_dwordx4 v1, s[12:15], s85 offen lds
    v_fmamk_f32 v60, v12, 0x42400000, v14
    v_fmamk_f32 v61, v13, 0x42400000, v15
    v_fract_f32 v60, v60
    v_fract_f32 v61, v61
    v_cos_f32 v62, v60
    v_sin_f32 v60, v60
    s_add_u32 s85, s50, 524288
    s_add_u32 m0, s72, 2080
    s_nop 0
    buffer_load_dwordx4 v1, s[12:15], s85 offen lds
    v_cos_f32 v63, v61
    v_sin_f32 v61, v61
    v_cvt_pk_f16_f32 v205, v62, v60
    v_cvt_pk_f16_f32 v221, v63, v61
    s_add_u32 s85, s50, 786432
    s_add_u32 m0, s72, 3120
    s_nop 0
    buffer_load_dwordx4 v1, s[12:15], s85 offen lds
    v_fmamk_f32 v60, v12, 0x41880000, v14
    v_fmamk_f32 v61, v13, 0x41880000, v15
    v_fract_f32 v60, v60
    v_fract_f32 v61, v61
    v_cos_f32 v62, v60
    v_sin_f32 v60, v60
    s_add_u32 s85, s50, 1048576
    s_add_u32 m0, s72, 4160
    s_nop 0
    buffer_load_dwordx4 v1, s[12:15], s85 offen lds
    v_cos_f32 v63, v61
    v_sin_f32 v61, v61
    v_cvt_pk_f16_f32 v206, v62, v60
    v_cvt_pk_f16_f32 v222, v63, v61
    s_add_u32 s85, s50, 1310720
    s_add_u32 m0, s72, 5200
    s_nop 0
    buffer_load_dwordx4 v1, s[12:15], s85 offen lds
    v_fmamk_f32 v60, v12, 0x42440000, v14
    v_fmamk_f32 v61, v13, 0x42440000, v15
    v_fract_f32 v60, v60
    v_fract_f32 v61, v61
    v_cos_f32 v62, v60
    v_sin_f32 v60, v60
    s_add_u32 s85, s50, 1572864
    s_add_u32 m0, s72, 6240
    s_nop 0
    buffer_load_dwordx4 v1, s[12:15], s85 offen lds
    v_cos_f32 v63, v61
    v_sin_f32 v61, v61
    v_cvt_pk_f16_f32 v207, v62, v60
    v_cvt_pk_f16_f32 v223, v63, v61
    s_add_u32 s85, s50, 1835008
    s_add_u32 m0, s72, 7280
    s_nop 0
    buffer_load_dwordx4 v1, s[12:15], s85 offen lds
    v_fmamk_f32 v60, v12, 0x41c00000, v14
    v_fmamk_f32 v61, v13, 0x41c00000, v15
    v_fract_f32 v60, v60
    v_fract_f32 v61, v61
    v_cos_f32 v62, v60
    v_sin_f32 v60, v60
    s_add_u32 s85, s50, 2097152
    s_add_u32 m0, s72, 8320
    s_nop 0
    buffer_load_dwordx4 v1, s[12:15], s85 offen lds
    v_cos_f32 v63, v61
    v_sin_f32 v61, v61
    v_cvt_pk_f16_f32 v208, v62, v60
    v_cvt_pk_f16_f32 v224, v63, v61
    s_add_u32 s85, s50, 2359296
    s_add_u32 m0, s72, 9360
    s_nop 0
    buffer_load_dwordx4 v1, s[12:15], s85 offen lds
    v_fmamk_f32 v60, v12, 0x42600000, v14
    v_fmamk_f32 v61, v13, 0x42600000, v15
    v_fract_f32 v60, v60
    v_fract_f32 v61, v61
    v_cos_f32 v62, v60
    v_sin_f32 v60, v60
    s_add_u32 s85, s50, 2621440
    s_add_u32 m0, s72, 10400
    s_nop 0
    buffer_load_dwordx4 v1, s[12:15], s85 offen lds
    v_cos_f32 v63, v61
    v_sin_f32 v61, v61
    v_cvt_pk_f16_f32 v209, v62, v60
    v_cvt_pk_f16_f32 v225, v63, v61
    s_add_u32 s85, s50, 2883584
    s_add_u32 m0, s72, 11440
    s_nop 0
    buffer_load_dwordx4 v1, s[12:15], s85 offen lds
    v_fmamk_f32 v60, v12, 0x41c80000, v14
    v_fmamk_f32 v61, v13, 0x41c80000, v15
    v_fract_f32 v60, v60
    v_fract_f32 v61, v61
    v_cos_f32 v62, v60
    v_sin_f32 v60, v60
    s_add_u32 s85, s50, 3145728
    s_add_u32 m0, s72, 12480
    s_nop 0
    buffer_load_dwordx4 v1, s[12:15], s85 offen lds
    v_cos_f32 v63, v61
    v_sin_f32 v61, v61
    v_cvt_pk_f16_f32 v210, v62, v60
    v_cvt_pk_f16_f32 v226, v63, v61
    s_add_u32 s85, s50, 3407872
    s_add_u32 m0, s72, 13520
    s_nop 0
    buffer_load_dwordx4 v1, s[12:15], s85 offen lds
    v_fmamk_f32 v60, v12, 0x42640000, v14
    v_fmamk_f32 v61, v13, 0x42640000, v15
    v_fract_f32 v60, v60
    v_fract_f32 v61, v61
    v_cos_f32 v62, v60
    v_sin_f32 v60, v60
    s_add_u32 s85, s50, 3670016
    s_add_u32 m0, s72, 14560
    s_nop 0
    buffer_load_dwordx4 v1, s[12:15], s85 offen lds
    v_cos_f32 v63, v61
    v_sin_f32 v61, v61
    v_cvt_pk_f16_f32 v211, v62, v60
    v_cvt_pk_f16_f32 v227, v63, v61
    s_add_u32 s85, s50, 3932160
    s_add_u32 m0, s72, 15600
    s_nop 0
    buffer_load_dwordx4 v1, s[12:15], s85 offen lds
    s_waitcnt vmcnt(16)
    v_cmp_gt_u32 vcc, 0x2000, v251
    s_cbranch_vccnz L_rt_8
L_bk_9:
    v_readlane_b32 s78, v250, s70
    s_nop 0
    s_or_b32 s78, s78, s77
    s_cmp_lg_u32 s78, -1
    s_cbranch_scc1 L_fix
    s_mov_b32 s77, 0
    s_mov_b32 s16, s52
    s_mov_b32 s17, s53
    s_mov_b32 s18, 0x1000
    s_mov_b32 s19, 0x20000
    s_lshr_b32 s78, s48, 12
    s_lshl_b32 s78, s78, 1
    v_lshlrev_b32 v250, 7, v2
    buffer_load_ushort v4, v250, s[16:19], s78 offen
    buffer_load_dword v250, v230, s[4:7], s33 offen sc1
    s_add_u32 s78, s32, 0
    buffer_load_dwordx4 v[96:99], v228, s[4:7], s78 offen offset:0 sc1
    buffer_load_dwordx4 v[100:103], v228, s[4:7], s78 offen offset:2048 sc1
    s_add_u32 s78, s32, 16384
    buffer_load_dwordx4 v[104:107], v228, s[4:7], s78 offen offset:0 sc1
    buffer_load_dwordx4 v[108:111], v228, s[4:7], s78 offen offset:2048 sc1
    s_add_u32 s78, s32, 32768
    buffer_load_dwordx4 v[112:115], v228, s[4:7], s78 offen offset:0 sc1
    buffer_load_dwordx4 v[116:119], v228, s[4:7], s78 offen offset:2048 sc1
    s_add_u32 s78, s32, 49152
    buffer_load_dwordx4 v[120:123], v228, s[4:7], s78 offen offset:0 sc1
    buffer_load_dwordx4 v[124:127], v228, s[4:7], s78 offen offset:2048 sc1
    ds_read_b64 a[4:5], v57 offset:0
    ds_read_b64 a[6:7], v57 offset:128
    ds_read_b64 a[20:21], v57 offset:64
    ds_read_b64 a[22:23], v57 offset:192
    ds_read_b64 a[36:37], v57 offset:8
    ds_read_b64 a[38:39], v57 offset:136
    ds_read_b64 a[52:53], v57 offset:72
    ds_read_b64 a[54:55], v57 offset:200
    ds_read_b64 a[68:69], v57 offset:16
    ds_read_b64 a[70:71], v57 offset:144
    ds_read_b64 a[84:85], v57 offset:80
    ds_read_b64 a[86:87], v57 offset:208
    ds_read_b64 a[100:101], v57 offset:24
    ds_read_b64 a[102:103], v57 offset:152
    ds_read_b64 a[116:117], v57 offset:88
    ds_read_b64 a[118:119], v57 offset:216
    ds_read_b64 a[132:133], v57 offset:32
    ds_read_b64 a[134:135], v57 offset:160
    ds_read_b64 a[148:149], v57 offset:96
    ds_read_b64 a[150:151], v57 offset:224
    ds_read_b64 a[164:165], v57 offset:40
    ds_read_b64 a[166:167], v57 offset:168
    ds_read_b64 a[180:181], v57 offset:104
    ds_read_b64 a[182:183], v57 offset:232
    ds_read_b64 a[196:197], v57 offset:48
    ds_read_b64 a[198:199], v57 offset:176
    ds_read_b64 a[212:213], v57 offset:112
    ds_read_b64 a[214:215], v57 offset:240
    ds_read_b64 a[228:229], v57 offset:56
    ds_read_b64 a[230:231], v57 offset:184
    ds_read_b64 a[244:245], v57 offset:120
    ds_read_b64 a[246:247], v57 offset:248
    s_waitcnt lgkmcnt(0)
    v_lshlrev_b32 v16, 16, v44
    v_and_b32 v20, 0xffff0000, v44
    v_lshlrev_b32 v17, 16, v45
    v_and_b32 v21, 0xffff0000, v45
    v_lshlrev_b32 v18, 16, v46
    v_and_b32 v22, 0xffff0000, v46
    v_lshlrev_b32 v19, 16, v47
    v_and_b32 v23, 0xffff0000, v47
    v_mov_b32 v54, v16
    v_lshlrev_b32 v24, 16, v48
    v_and_b32 v28, 0xffff0000, v48
    v_lshlrev_b32 v25, 16, v49
    v_and_b32 v29, 0xffff0000, v49
    v_lshlrev_b32 v26, 16, v50
    v_and_b32 v30, 0xffff0000, v50
    v_lshlrev_b32 v27, 16, v51
    v_and_b32 v31, 0xffff0000, v51
    v_mov_b32 v55, v24
    buffer_load_dword v254, v231, s[4:7], s34 offen offset:0
    buffer_load_dword v254, v229, s[4:7], s31 offen offset:0
    buffer_load_ubyte v254, v2, s[4:7], s91 offen
    s_add_u32 s85, s51, 0
    s_add_u32 m0, s72, 67584
    s_nop 0
    buffer_load_dwordx4 v1, s[12:15], s85 offen lds
    s_add_u32 s85, s51, 262144
    s_add_u32 m0, s72, 68624
    s_nop 0
    buffer_load_dwordx4 v1, s[12:15], s85 offen lds
    s_add_u32 s85, s51, 524288
    s_add_u32 m0, s72, 69664
    s_nop 0
    buffer_load_dwordx4 v1, s[12:15], s85 offen lds
    s_add_u32 s85, s51, 786432
    s_add_u32 m0, s72, 70704
    s_nop 0
    buffer_load_dwordx4 v1, s[12:15], s85 offen lds
    s_add_u32 s85, s51, 1048576
    s_add_u32 m0, s72, 71744
    s_nop 0
    buffer_load_dwordx4 v1, s[12:15], s85 offen lds
    s_add_u32 s85, s51, 1310720
    s_add_u32 m0, s72, 72784
    s_nop 0
    buffer_load_dwordx4 v1, s[12:15], s85 offen lds
    s_add_u32 s85, s51, 1572864
    s_add_u32 m0, s72, 73824
    s_nop 0
    buffer_load_dwordx4 v1, s[12:15], s85 offen lds
    s_add_u32 s85, s51, 1835008
    s_add_u32 m0, s72, 74864
    s_nop 0
    buffer_load_dwordx4 v1, s[12:15], s85 offen lds
    s_add_u32 s85, s51, 2097152
    s_add_u32 m0, s72, 75904
    s_nop 0
    buffer_load_dwordx4 v1, s[12:15], s85 offen lds
    s_add_u32 s85, s51, 2359296
    s_add_u32 m0, s72, 76944
    s_nop 0
    buffer_load_dwordx4 v1, s[12:15], s85 offen lds
    s_add_u32 s85, s51, 2621440
    s_add_u32 m0, s72, 77984
    s_nop 0
    buffer_load_dwordx4 v1, s[12:15], s85 offen lds
    s_add_u32 s85, s51, 2883584
    s_add_u32 m0, s72, 79024
    s_nop 0
    buffer_load_dwordx4 v1, s[12:15], s85 offen lds
    s_waitcnt vmcnt(15)
    v_lshlrev_b32 v4, 16, v4
    v_max3_u32 v12, v250, v96, v98
    v_max3_u32 v12, v12, v100, v102
    v_max3_u32 v12, v12, v104, v106
    v_max3_u32 v12, v12, v108, v110
    v_max3_u32 v12, v12, v112, v114
    v_max3_u32 v12, v12, v116, v118
    v_max3_u32 v12, v12, v120, v122
    v_max3_u32 v12, v12, v124, v126
    v_cmp_eq_u32 vcc, -1, v12
    s_cbranch_vccnz L_rt_10
L_bk_11:
    s_branch L_p1j_4
L_p1b_3:
    s_nop 7
    buffer_load_dwordx4 v[44:47], v1, s[4:7], s29 offen sc1
    buffer_load_dwordx4 v[48:51], v1, s[4:7], s30 offen sc1
    buffer_load_dword v254, v231, s[4:7], s34 offen offset:0
    s_and_b32 s82, s62, 2
    s_lshl2_add_u32 s83, s63, s64
    s_and_b32 s84, s82, 1
    s_lshl_b32 s84, s84, 5
    s_add_u32 s83, s83, s84
    s_lshr_b32 s84, s82, 1
    s_lshl_b32 s84, s84, 10
    s_add_u32 s83, s83, s84
    s_and_b32 s84, s65, 4
    s_lshl_b32 s84, s84, 29
    s_or_b32 s84, s84, 0x3a000000
    v_lshl_add_u32 v12, v2, 6, s83
    v_add_u32 v13, 32, v12
    v_cvt_f32_u32 v12, v12
    v_cvt_f32_u32 v13, v13
    v_mul_f32 v12, s84, v12
    v_mul_f32 v13, s84, v13
    v_lshlrev_b32 v15, 1, v3
    v_cvt_f32_u32 v15, v15
    v_mul_f32 v14, v15, v12
    v_mul_f32 v15, v15, v13
    s_add_u32 s85, s88, 0xe1000
    s_add_u32 m0, s69, 0x1000
    s_nop 0
    buffer_load_dwordx4 v1, s[4:7], s85 offen offset:2048 sc1 lds
    v_fmamk_f32 v60, v12, 0x0, v14
    v_fmamk_f32 v61, v13, 0x0, v15
    v_fract_f32 v60, v60
    v_fract_f32 v61, v61
    v_cos_f32 v62, v60
    v_sin_f32 v60, v60
    s_add_u32 s85, s88, 0xe7000
    s_add_u32 m0, s69, 0x7000
    s_nop 0
    buffer_load_dwordx4 v1, s[4:7], s85 offen offset:0 sc1 lds
    v_cos_f32 v63, v61
    v_sin_f32 v61, v61
    v_cvt_pk_f16_f32 v196, v62, v60
    v_cvt_pk_f16_f32 v212, v63, v61
    buffer_load_dwordx4 v1, s[4:7], s85 offen offset:1024 sc1 lds
    v_fmamk_f32 v60, v12, 0x42000000, v14
    v_fmamk_f32 v61, v13, 0x42000000, v15
    v_fract_f32 v60, v60
    v_fract_f32 v61, v61
    v_cos_f32 v62, v60
    v_sin_f32 v60, v60
    buffer_load_dwordx4 v1, s[4:7], s85 offen offset:2048 sc1 lds
    v_cos_f32 v63, v61
    v_sin_f32 v61, v61
    v_cvt_pk_f16_f32 v197, v62, v60
    v_cvt_pk_f16_f32 v213, v63, v61
    buffer_load_dwordx4 v1, s[4:7], s85 offen offset:3072 sc1 lds
    v_fmamk_f32 v60, v12, 0x3f800000, v14
    v_fmamk_f32 v61, v13, 0x3f800000, v15
    v_fract_f32 v60, v60
    v_fract_f32 v61, v61
    v_cos_f32 v62, v60
    v_sin_f32 v60, v60
    s_add_u32 s85, s88, 0xe8000
    s_add_u32 m0, s69, 0x8000
    s_nop 0
    buffer_load_dwordx4 v1, s[4:7], s85 offen offset:0 sc1 lds
    v_cos_f32 v63, v61
    v_sin_f32 v61, v61
    v_cvt_pk_f16_f32 v198, v62, v60
    v_cvt_pk_f16_f32 v214, v63, v61
    buffer_load_dwordx4 v1, s[4:7], s85 offen offset:1024 sc1 lds
    v_fmamk_f32 v60, v12, 0x42040000, v14
    v_fmamk_f32 v61, v13, 0x42040000, v15
    v_fract_f32 v60, v60
    v_fract_f32 v61, v61
    v_cos_f32 v62, v60
    v_sin_f32 v60, v60
    buffer_load_dwordx4 v1, s[4:7], s85 offen offset:2048 sc1 lds
    v_cos_f32 v63, v61
    v_sin_f32 v61, v61
    v_cvt_pk_f16_f32 v199, v62, v60
    v_cvt_pk_f16_f32 v215, v63, v61
    s_add_u32 s85, s88, 0xf5000
    s_add_u32 m0, s69, 0xe000
    s_nop 0
    buffer_load_dwordx4 v1, s[4:7], s85 offen offset:0 sc1 lds
    v_fmamk_f32 v60, v12, 0x41000000, v14
    v_fmamk_f32 v61, v13, 0x41000000, v15
    v_fract_f32 v60, v60
    v_fract_f32 v61, v61
    v_cos_f32 v62, v60
    v_sin_f32 v60, v60
    buffer_load_dwordx4 v1, s[4:7], s85 offen offset:1024 sc1 lds
    v_cos_f32 v63, v61
    v_sin_f32 v61, v61
    v_cvt_pk_f16_f32 v200, v62, v60
    v_cvt_pk_f16_f32 v216, v63, v61
    buffer_load_dwordx4 v1, s[4:7], s85 offen offset:2048 sc1 lds
    v_fmamk_f32 v60, v12, 0x42200000, v14
    v_fmamk_f32 v61, v13, 0x42200000, v15
    v_fract_f32 v60, v60
    v_fract_f32 v61, v61
    v_cos_f32 v62, v60
    v_sin_f32 v60, v60
    buffer_load_dwordx4 v1, s[4:7], s85 offen offset:3072 sc1 lds
    v_cos_f32 v63, v61
    v_sin_f32 v61, v61
    v_cvt_pk_f16_f32 v201, v62, v60
    v_cvt_pk_f16_f32 v217, v63, v61
    s_add_u32 s85, s88, 0xf6000
    s_add_u32 m0, s69, 0xf000
    s_nop 0
    buffer_load_dwordx4 v1, s[4:7], s85 offen offset:0 sc1 lds
    v_fmamk_f32 v60, v12, 0x41100000, v14
    v_fmamk_f32 v61, v13, 0x41100000, v15
    v_fract_f32 v60, v60
    v_fract_f32 v61, v61
    v_cos_f32 v62, v60
    v_sin_f32 v60, v60
    buffer_load_dwordx4 v1, s[4:7], s85 offen offset:1024 sc1 lds
    v_cos_f32 v63, v61
    v_sin_f32 v61, v61
    v_cvt_pk_f16_f32 v202, v62, v60
    v_cvt_pk_f16_f32 v218, v63, v61
    buffer_load_dwordx4 v1, s[4:7], s85 offen offset:2048 sc1 lds
    v_fmamk_f32 v60, v12, 0x42240000, v14
    v_fmamk_f32 v61, v13, 0x42240000, v15
    v_fract_f32 v60, v60
    v_fract_f32 v61, v61
    v_cos_f32 v62, v60
    v_sin_f32 v60, v60
    v_cos_f32 v63, v61
    v_sin_f32 v61, v61
    v_cvt_pk_f16_f32 v203, v62, v60
    v_cvt_pk_f16_f32 v219, v63, v61
    s_waitcnt vmcnt(16)
    buffer_load_dword v250, v230, s[4:7], s33 offen sc1
    s_add_u32 s78, s32, 0
    buffer_load_dwordx4 v[96:99], v228, s[4:7], s78 offen offset:0 sc1
    buffer_load_dwordx4 v[100:103], v228, s[4:7], s78 offen offset:2048 sc1
    s_add_u32 s78, s32, 16384
    buffer_load_dwordx4 v[104:107], v228, s[4:7], s78 offen offset:0 sc1
    buffer_load_dwordx4 v[108:111], v228, s[4:7], s78 offen offset:2048 sc1
    s_add_u32 s78, s32, 32768
    buffer_load_dwordx4 v[112:115], v228, s[4:7], s78 offen offset:0 sc1
    buffer_load_dwordx4 v[116:119], v228, s[4:7], s78 offen offset:2048 sc1
    s_add_u32 s78, s32, 49152
    buffer_load_dwordx4 v[120:123], v228, s[4:7], s78 offen offset:0 sc1
    buffer_load_dwordx4 v[124:127], v228, s[4:7], s78 offen offset:2048 sc1
    s_barrier
    v_fmamk_f32 v60, v12, 0x41800000, v14
    v_fmamk_f32 v61, v13, 0x41800000, v15
    v_fract_f32 v60, v60
    v_fract_f32 v61, v61
    v_cos_f32 v62, v60
    v_sin_f32 v60, v60
    v_cos_f32 v63, v61
    v_sin_f32 v61, v61
    v_cvt_pk_f16_f32 v204, v62, v60
    v_cvt_pk_f16_f32 v220, v63, v61
    v_fmamk_f32 v60, v12, 0x42400000, v14
    v_fmamk_f32 v61, v13, 0x42400000, v15
    v_fract_f32 v60, v60
    v_fract_f32 v61, v61
    v_cos_f32 v62, v60
    v_sin_f32 v60, v60
    s_add_u32 s85, s88, 0xee000
    s_add_u32 m0, s69, 0x1c000
    s_nop 0
    buffer_load_dwordx4 v1, s[4:7], s85 offen offset:0 sc1 lds
    v_cos_f32 v63, v61
    v_sin_f32 v61, v61
    v_cvt_pk_f16_f32 v205, v62, v60
    v_cvt_pk_f16_f32 v221, v63, v61
    v_fmamk_f32 v60, v12, 0x41880000, v14
    v_fmamk_f32 v61, v13, 0x41880000, v15
    v_fract_f32 v60, v60
    v_fract_f32 v61, v61
    v_cos_f32 v62, v60
    v_sin_f32 v60, v60
    v_cos_f32 v63, v61
    v_sin_f32 v61, v61
    v_cvt_pk_f16_f32 v206, v62, v60
    v_cvt_pk_f16_f32 v222, v63, v61
    buffer_load_dwordx4 v1, s[4:7], s85 offen offset:1024 sc1 lds
    v_fmamk_f32 v60, v12, 0x42440000, v14
    v_fmamk_f32 v61, v13, 0x42440000, v15
    v_fract_f32 v60, v60
    v_fract_f32 v61, v61
    v_cos_f32 v62, v60
    v_sin_f32 v60, v60
    v_cos_f32 v63, v61
    v_sin_f32 v61, v61
    v_cvt_pk_f16_f32 v207, v62, v60
    v_cvt_pk_f16_f32 v223, v63, v61
    v_fmamk_f32 v60, v12, 0x41c00000, v14
    v_fmamk_f32 v61, v13, 0x41c00000, v15
    v_fract_f32 v60, v60
    v_fract_f32 v61, v61
    v_cos_f32 v62, v60
    v_sin_f32 v60, v60
    buffer_load_dwordx4 v1, s[4:7], s85 offen offset:2048 sc1 lds
    v_cos_f32 v63, v61
    v_sin_f32 v61, v61
    v_cvt_pk_f16_f32 v208, v62, v60
    v_cvt_pk_f16_f32 v224, v63, v61
    v_fmamk_f32 v60, v12, 0x42600000, v14
    v_fmamk_f32 v61, v13, 0x42600000, v15
    v_fract_f32 v60, v60
    v_fract_f32 v61, v61
    v_cos_f32 v62, v60
    v_sin_f32 v60, v60
    v_cos_f32 v63, v61
    v_sin_f32 v61, v61
    v_cvt_pk_f16_f32 v209, v62, v60
    v_cvt_pk_f16_f32 v225, v63, v61
    buffer_load_dwordx4 v1, s[4:7], s85 offen offset:3072 sc1 lds
    v_fmamk_f32 v60, v12, 0x41c80000, v14
    v_fmamk_f32 v61, v13, 0x41c80000, v15
    v_fract_f32 v60, v60
    v_fract_f32 v61, v61
    v_cos_f32 v62, v60
    v_sin_f32 v60, v60
    v_cos_f32 v63, v61
    v_sin_f32 v61, v61
    v_cvt_pk_f16_f32 v210, v62, v60
    v_cvt_pk_f16_f32 v226, v63, v61
    v_fmamk_f32 v60, v12, 0x42640000, v14
    v_fmamk_f32 v61, v13, 0x42640000, v15
    v_fract_f32 v60, v60
    v_fract_f32 v61, v61
    v_cos_f32 v62, v60
    v_sin_f32 v60, v60
    s_add_u32 s85, s88, 0xef000
    s_add_u32 m0, s69, 0x1d000
    s_nop 0
    buffer_load_dwordx4 v1, s[4:7], s85 offen offset:0 sc1 lds
    v_cos_f32 v63, v61
    v_sin_f32 v61, v61
    v_cvt_pk_f16_f32 v211, v62, v60
    v_cvt_pk_f16_f32 v227, v63, v61
    v_lshlrev_b32 v16, 16, v44
    v_and_b32 v20, 0xffff0000, v44
    v_lshlrev_b32 v17, 16, v45
    v_and_b32 v21, 0xffff0000, v45
    buffer_load_dwordx4 v1, s[4:7], s85 offen offset:1024 sc1 lds
    v_lshlrev_b32 v18, 16, v46
    v_and_b32 v22, 0xffff0000, v46
    v_lshlrev_b32 v19, 16, v47
    v_and_b32 v23, 0xffff0000, v47
    v_mov_b32 v54, v16
    buffer_load_dwordx4 v1, s[4:7], s85 offen offset:2048 sc1 lds
    v_lshlrev_b32 v24, 16, v48
    v_and_b32 v28, 0xffff0000, v48
    v_lshlrev_b32 v25, 16, v49
    v_and_b32 v29, 0xffff0000, v49
    v_lshlrev_b32 v26, 16, v50
    v_and_b32 v30, 0xffff0000, v50
    v_lshlrev_b32 v27, 16, v51
    v_and_b32 v31, 0xffff0000, v51
    v_mov_b32 v55, v24
L_p1j_4:
    s_cmp_ge_u32 s65, 4
    s_cbranch_scc1 L_mir_12
    s_waitcnt vmcnt(13)
    v_swap_b32 v98, v100
    v_swap_b32 v99, v101
    v_max3_u32 v250, v250, v96, v98
    v_max3_u32 v250, v250, v100, v102
    v_mfma_f32_16x16x32_f16 v[16:19], v[96:99], v[196:199], v[16:19]
    v_mfma_f32_16x16x32_f16 v[20:23], v[100:103], v[196:199], v[20:23]
    v_mfma_f32_16x16x32_f16 v[24:27], v[96:99], v[212:215], v[24:27]
    v_mfma_f32_16x16x32_f16 v[28:31], v[100:103], v[212:215], v[28:31]
    s_waitcnt vmcnt(11)
    v_swap_b32 v106, v108
    v_swap_b32 v107, v109
    v_max3_u32 v250, v250, v104, v106
    v_max3_u32 v250, v250, v108, v110
    v_mfma_f32_16x16x32_f16 v[16:19], v[104:107], v[200:203], v[16:19]
    v_mfma_f32_16x16x32_f16 v[20:23], v[108:111], v[200:203], v[20:23]
    v_mfma_f32_16x16x32_f16 v[24:27], v[104:107], v[216:219], v[24:27]
    v_mfma_f32_16x16x32_f16 v[28:31], v[108:111], v[216:219], v[28:31]
    s_waitcnt vmcnt(9)
    v_swap_b32 v114, v116
    v_swap_b32 v115, v117
    v_max3_u32 v250, v250, v112, v114
    v_max3_u32 v250, v250, v116, v118
    v_mfma_f32_16x16x32_f16 v[16:19], v[112:115], v[204:207], v[16:19]
    v_mfma_f32_16x16x32_f16 v[20:23], v[116:119], v[204:207], v[20:23]
    v_mfma_f32_16x16x32_f16 v[24:27], v[112:115], v[220:223], v[24:27]
    v_mfma_f32_16x16x32_f16 v[28:31], v[116:119], v[220:223], v[28:31]
    s_waitcnt vmcnt(7)
    v_swap_b32 v122, v124
    v_swap_b32 v123, v125
    v_max3_u32 v250, v250, v120, v122
    v_max3_u32 v250, v250, v124, v126
    v_mfma_f32_16x16x32_f16 v[16:19], v[120:123], v[208:211], v[16:19]
    v_mfma_f32_16x16x32_f16 v[20:23], v[124:127], v[208:211], v[20:23]
    v_mfma_f32_16x16x32_f16 v[24:27], v[120:123], v[224:227], v[24:27]
    v_mfma_f32_16x16x32_f16 v[28:31], v[124:127], v[224:227], v[28:31]
    s_branch L_mire_13
L_mir_12:
    s_waitcnt vmcnt(13)
    v_swap_b32 v98, v100
    v_swap_b32 v99, v101
    v_max3_u32 v250, v250, v96, v98
    v_max3_u32 v250, v250, v100, v102
    v_mfma_f32_16x16x32_f16 v[16:19], v[100:103], v[196:199], v[16:19]
    v_mfma_f32_16x16x32_f16 v[20:23], v[96:99], v[196:199], v[20:23]
    v_mfma_f32_16x16x32_f16 v[24:27], v[100:103], v[212:215], v[24:27]
    v_mfma_f32_16x16x32_f16 v[28:31], v[96:99], v[212:215], v[28:31]
    s_waitcnt vmcnt(11)
    v_swap_b32 v106, v108
    v_swap_b32 v107, v109
    v_max3_u32 v250, v250, v104, v106
    v_max3_u32 v250, v250, v108, v110
    v_mfma_f32_16x16x32_f16 v[16:19], v[108:111], v[200:203], v[16:19]
    v_mfma_f32_16x16x32_f16 v[20:23], v[104:107], v[200:203], v[20:23]
    v_mfma_f32_16x16x32_f16 v[24:27], v[108:111], v[216:219], v[24:27]
    v_mfma_f32_16x16x32_f16 v[28:31], v[104:107], v[216:219], v[28:31]
    s_waitcnt vmcnt(9)
    v_swap_b32 v114, v116
    v_swap_b32 v115, v117
    v_max3_u32 v250, v250, v112, v114
    v_max3_u32 v250, v250, v116, v118
    v_mfma_f32_16x16x32_f16 v[16:19], v[116:119], v[204:207], v[16:19]
    v_mfma_f32_16x16x32_f16 v[20:23], v[112:115], v[204:207], v[20:23]
    v_mfma_f32_16x16x32_f16 v[24:27], v[116:119], v[220:223], v[24:27]
    v_mfma_f32_16x16x32_f16 v[28:31], v[112:115], v[220:223], v[28:31]
    s_waitcnt vmcnt(7)
    v_swap_b32 v122, v124
    v_swap_b32 v123, v125
    v_max3_u32 v250, v250, v120, v122
    v_max3_u32 v250, v250, v124, v126
    v_mfma_f32_16x16x32_f16 v[16:19], v[124:127], v[208:211], v[16:19]
    v_mfma_f32_16x16x32_f16 v[20:23], v[120:123], v[208:211], v[20:23]
    v_mfma_f32_16x16x32_f16 v[24:27], v[124:127], v[224:227], v[24:27]
    v_mfma_f32_16x16x32_f16 v[28:31], v[120:123], v[224:227], v[28:31]
L_mire_13:
    v_cmp_eq_u32 vcc, -1, v250
    s_cbranch_vccnz L_redo_14
L_gu_16:
    s_nop 2
    v_cndmask_b32 v16, v16, v54, s[86:87]
    v_cvt_pk_bf16_f32 v32, v16, v20
    v_cvt_pk_bf16_f32 v33, v17, v21
    v_cvt_pk_bf16_f32 v34, v18, v22
    v_cvt_pk_bf16_f32 v35, v19, v23
    v_cndmask_b32 v24, v24, v55, s[86:87]
    v_cvt_pk_bf16_f32 v36, v24, v28
    v_cvt_pk_bf16_f32 v37, v25, v29
    v_cvt_pk_bf16_f32 v38, v26, v30
    v_cvt_pk_bf16_f32 v39, v27, v31
    s_cmp_lg_u32 s66, 1
    s_cbranch_scc1 L_skip_17
    buffer_store_dwordx4 v[32:35], v1, s[4:7], s29 offen
    buffer_store_dwordx4 v[36:39], v1, s[4:7], s30 offen
    v_dot2_f32_bf16 v12, v32, s71, 0
    v_dot2_f32_bf16 v13, v32, v32, 0
    v_dot2_f32_bf16 v14, v36, s71, 0
    v_dot2_f32_bf16 v15, v36, v36, 0
    v_dot2c_f32_bf16 v12, s71, v33
    v_dot2c_f32_bf16 v13, v33, v33
    v_dot2c_f32_bf16 v14, s71, v37
    v_dot2c_f32_bf16 v15, v37, v37
    v_dot2c_f32_bf16 v12, s71, v34
    v_dot2c_f32_bf16 v13, v34, v34
    v_dot2c_f32_bf16 v14, s71, v38
    v_dot2c_f32_bf16 v15, v38, v38
    v_dot2c_f32_bf16 v12, s71, v35
    v_dot2c_f32_bf16 v13, v35, v35
    v_dot2c_f32_bf16 v14, s71, v39
    v_dot2c_f32_bf16 v15, v39, v39
    s_nop 0
    v_permlane32_swap_b32 v12, v13
    s_nop 0
    v_permlane32_swap_b32 v14, v15
    v_add_f32 v12, v12, v13
    v_add_f32 v14, v14, v15
    s_nop 1
    v_permlane16_swap_b32 v12, v14
    v_add_f32 v12, v12, v14
    v_and_or_b32 v14, v12, -4, s54
    s_waitcnt vmcnt(0)
    buffer_store_dword v14, v229, s[4:7], s31 offen
    s_barrier
L_skip_17:
    s_cmp_lg_u32 s66, 0
    s_cbranch_scc1 L_skip_18
    buffer_store_dwordx4 v[32:35], v1, s[4:7], s29 offen sc1
    buffer_store_dwordx4 v[36:39], v1, s[4:7], s30 offen sc1
    v_dot2_f32_bf16 v12, v32, s71, 0
    v_dot2_f32_bf16 v13, v32, v32, 0
    v_dot2_f32_bf16 v14, v36, s71, 0
    v_dot2_f32_bf16 v15, v36, v36, 0
    v_dot2c_f32_bf16 v12, s71, v33
    v_dot2c_f32_bf16 v13, v33, v33
    v_dot2c_f32_bf16 v14, s71, v37
    v_dot2c_f32_bf16 v15, v37, v37
    v_dot2c_f32_bf16 v12, s71, v34
    v_dot2c_f32_bf16 v13, v34, v34
    v_dot2c_f32_bf16 v14, s71, v38
    v_dot2c_f32_bf16 v15, v38, v38
    v_dot2c_f32_bf16 v12, s71, v35
    v_dot2c_f32_bf16 v13, v35, v35
    v_dot2c_f32_bf16 v14, s71, v39
    v_dot2c_f32_bf16 v15, v39, v39
    s_nop 0
    v_permlane32_swap_b32 v12, v13
    s_nop 0
    v_permlane32_swap_b32 v14, v15
    v_add_f32 v12, v12, v13
    v_add_f32 v14, v14, v15
    s_nop 1
    v_permlane16_swap_b32 v12, v14
    v_add_f32 v12, v12, v14
    v_and_or_b32 v14, v12, -4, s54
    v_lshrrev_b32 v12, 5, v0
    s_lshl_b32 s78, s62, 2
    v_add_u32 v12, s78, v12
    v_and_b32 v13, 7, v0
    v_mul_u32_u24 v13, 112, v13
    v_bfe_u32 v15, v0, 3, 2
    v_lshlrev_b32 v15, 4, v15
    s_mul_i32 s78, s65, 896
    s_add_u32 s78, s78, 65536
    v_add_u32 v24, 0, v12
    v_min_u32 v24, 13, v24
    v_lshl_add_u32 v26, v24, 6, v15
    v_add_u32 v26, 158976, v26
    v_cmp_le_u32 vcc, 7, v24
    v_add_u32 v24, v24, v13
    s_nop 0
    v_cndmask_b32 v28, 0, 49, vcc
    v_add_u32 v24, v24, v28
    v_lshl_add_u32 v24, v24, 7, v15
    v_add_u32 v25, 2, v12
    v_min_u32 v25, 13, v25
    v_lshl_add_u32 v27, v25, 6, v15
    v_add_u32 v27, 158976, v27
    v_cmp_le_u32 vcc, 7, v25
    v_add_u32 v25, v25, v13
    s_nop 0
    v_cndmask_b32 v28, 0, 49, vcc
    v_add_u32 v25, v25, v28
    v_lshl_add_u32 v25, v25, 7, v15
    s_waitcnt vmcnt(2)
    ds_read_b64 a[8:9], v56 offset:0
    ds_read_b64 a[10:11], v56 offset:128
    s_add_u32 s85, s51, 3145728
    s_add_u32 m0, s72, 80064
    s_nop 0
    buffer_load_dwordx4 v1, s[12:15], s85 offen lds
    ds_read_b64 a[24:25], v56 offset:64
    ds_read_b64 a[26:27], v56 offset:192
    s_add_u32 s85, s51, 3407872
    s_add_u32 m0, s72, 81104
    s_nop 0
    buffer_load_dwordx4 v1, s[12:15], s85 offen lds
    ds_read_b64 a[40:41], v56 offset:8
    ds_read_b64 a[42:43], v56 offset:136
    s_add_u32 s85, s51, 3670016
    s_add_u32 m0, s72, 82144
    s_nop 0
    buffer_load_dwordx4 v1, s[12:15], s85 offen lds
    ds_read_b64 a[56:57], v56 offset:72
    ds_read_b64 a[58:59], v56 offset:200
    s_add_u32 s85, s51, 3932160
    s_add_u32 m0, s72, 83184
    s_nop 0
    buffer_load_dwordx4 v1, s[12:15], s85 offen lds
    ds_read_b64 a[72:73], v56 offset:16
    ds_read_b64 a[74:75], v56 offset:144
    ds_read_b64 a[88:89], v56 offset:80
    ds_read_b64 a[90:91], v56 offset:208
    ds_read_b64 a[104:105], v56 offset:24
    ds_read_b64 a[106:107], v56 offset:152
    ds_read_b64 a[120:121], v56 offset:88
    ds_read_b64 a[122:123], v56 offset:216
    ds_read_b64 a[136:137], v56 offset:32
    ds_read_b64 a[138:139], v56 offset:160
    ds_read_b64 a[152:153], v56 offset:96
    ds_read_b64 a[154:155], v56 offset:224
    ds_read_b64 a[168:169], v56 offset:40
    ds_read_b64 a[170:171], v56 offset:168
    ds_read_b64 a[184:185], v56 offset:104
    ds_read_b64 a[186:187], v56 offset:232
    ds_read_b64 a[200:201], v56 offset:48
    ds_read_b64 a[202:203], v56 offset:176
    ds_read_b64 a[216:217], v56 offset:112
    ds_read_b64 a[218:219], v56 offset:240
    ds_read_b64 a[232:233], v56 offset:56
    ds_read_b64 a[234:235], v56 offset:184
    ds_read_b64 a[248:249], v56 offset:120
    ds_read_b64 a[250:251], v56 offset:248
    s_waitcnt lgkmcnt(0)
    s_waitcnt vmcnt(4)
    buffer_store_dword v14, v229, s[4:7], s31 offen
    s_barrier
    buffer_load_dwordx4 v[16:19], v24, s[4:7], s78 offen sc1
    buffer_load_dwordx4 v[20:23], v25, s[4:7], s78 offen sc1
    global_load_dword v254, v240, s[0:1]
    s_add_u32 s85, s88, 0xe0000
    s_add_u32 m0, s69, 0x0
    s_nop 0
    buffer_load_dwordx4 v1, s[4:7], s85 offen offset:0 sc1 lds
    buffer_load_dwordx4 v1, s[4:7], s85 offen offset:1024 sc1 lds
    buffer_load_dwordx4 v1, s[4:7], s85 offen offset:2048 sc1 lds
    buffer_load_dwordx4 v1, s[4:7], s85 offen offset:3072 sc1 lds
    s_add_u32 s85, s88, 0xe1000
    s_add_u32 m0, s69, 0x1000
    s_nop 0
    buffer_load_dwordx4 v1, s[4:7], s85 offen offset:0 sc1 lds
    buffer_load_dwordx4 v1, s[4:7], s85 offen offset:1024 sc1 lds
    buffer_load_dwordx4 v1, s[4:7], s85 offen offset:2048 sc1 lds
    s_add_u32 s85, s88, 0xe7000
    s_add_u32 m0, s69, 0x7000
    s_nop 0
    buffer_load_dwordx4 v1, s[4:7], s85 offen offset:0 sc1 lds
    s_waitcnt vmcnt(12)
    ds_read_b64 a[12:13], v57 offset:0
    ds_read_b64 a[14:15], v57 offset:128
    s_add_u32 s85, s88, 0xe7000
    s_add_u32 m0, s69, 0x7000
    s_nop 0
    buffer_load_dwordx4 v1, s[4:7], s85 offen offset:1024 sc1 lds
    ds_read_b64 a[28:29], v57 offset:64
    ds_read_b64 a[30:31], v57 offset:192
    buffer_load_dwordx4 v1, s[4:7], s85 offen offset:2048 sc1 lds
    ds_read_b64 a[44:45], v57 offset:8
    ds_read_b64 a[46:47], v57 offset:136
    buffer_load_dwordx4 v1, s[4:7], s85 offen offset:3072 sc1 lds
    ds_read_b64 a[60:61], v57 offset:72
    ds_read_b64 a[62:63], v57 offset:200
    s_add_u32 s85, s88, 0xe8000
    s_add_u32 m0, s69, 0x8000
    s_nop 0
    buffer_load_dwordx4 v1, s[4:7], s85 offen offset:0 sc1 lds
    ds_read_b64 a[76:77], v57 offset:16
    ds_read_b64 a[78:79], v57 offset:144
    buffer_load_dwordx4 v1, s[4:7], s85 offen offset:1024 sc1 lds
    ds_read_b64 a[92:93], v57 offset:80
    ds_read_b64 a[94:95], v57 offset:208
    buffer_load_dwordx4 v1, s[4:7], s85 offen offset:2048 sc1 lds
    ds_read_b64 a[108:109], v57 offset:24
    ds_read_b64 a[110:111], v57 offset:152
    ds_read_b64 a[124:125], v57 offset:88
    ds_read_b64 a[126:127], v57 offset:216
    ds_read_b64 a[140:141], v57 offset:32
    ds_read_b64 a[142:143], v57 offset:160
    ds_read_b64 a[156:157], v57 offset:96
    ds_read_b64 a[158:159], v57 offset:224
    ds_read_b64 a[172:173], v57 offset:40
    ds_read_b64 a[174:175], v57 offset:168
    ds_read_b64 a[188:189], v57 offset:104
    ds_read_b64 a[190:191], v57 offset:232
    ds_read_b64 a[204:205], v57 offset:48
    ds_read_b64 a[206:207], v57 offset:176
    ds_read_b64 a[220:221], v57 offset:112
    ds_read_b64 a[222:223], v57 offset:240
    ds_read_b64 a[236:237], v57 offset:56
    ds_read_b64 a[238:239], v57 offset:184
    ds_read_b64 a[252:253], v57 offset:120
    ds_read_b64 a[254:255], v57 offset:248
    s_waitcnt lgkmcnt(0)
    buffer_load_dwordx4 v[44:47], v1, s[4:7], s90 offen offset:0 sc1
    buffer_load_dwordx4 v[48:51], v1, s[4:7], s90 offen offset:1024 sc1
    s_barrier
    s_add_u32 s85, s88, 0xf5000
    s_add_u32 m0, s69, 0xe000
    s_nop 0
    buffer_load_dwordx4 v1, s[4:7], s85 offen offset:0 sc1 lds
    buffer_load_dwordx4 v1, s[4:7], s85 offen offset:1024 sc1 lds
    buffer_load_dwordx4 v1, s[4:7], s85 offen offset:2048 sc1 lds
    buffer_load_dwordx4 v1, s[4:7], s85 offen offset:3072 sc1 lds
    s_add_u32 s85, s88, 0xf6000
    s_add_u32 m0, s69, 0xf000
    s_nop 0
    buffer_load_dwordx4 v1, s[4:7], s85 offen offset:0 sc1 lds
    buffer_load_dwordx4 v1, s[4:7], s85 offen offset:1024 sc1 lds
    buffer_load_dwordx4 v1, s[4:7], s85 offen offset:2048 sc1 lds
    s_add_u32 s85, s88, 0xee000
    s_add_u32 m0, s69, 0x1c000
    s_nop 0
    buffer_load_dwordx4 v1, s[4:7], s85 offen offset:0 sc1 lds
    buffer_load_dwordx4 v1, s[4:7], s85 offen offset:1024 sc1 lds
    buffer_load_dwordx4 v1, s[4:7], s85 offen offset:2048 sc1 lds
    buffer_load_dwordx4 v1, s[4:7], s85 offen offset:3072 sc1 lds
    s_add_u32 s85, s88, 0xef000
    s_add_u32 m0, s69, 0x1d000
    s_nop 0
    buffer_load_dwordx4 v1, s[4:7], s85 offen offset:0 sc1 lds
    buffer_load_dwordx4 v1, s[4:7], s85 offen offset:1024 sc1 lds
    buffer_load_dwordx4 v1, s[4:7], s85 offen offset:2048 sc1 lds
    s_waitcnt vmcnt(14)
    v_add_f32_dpp v16, v16, v16 quad_perm:[1,0,3,2] row_mask:0xf bank_mask:0xf
    v_add_f32_dpp v17, v17, v17 quad_perm:[1,0,3,2] row_mask:0xf bank_mask:0xf
    v_add_f32_dpp v18, v18, v18 quad_perm:[1,0,3,2] row_mask:0xf bank_mask:0xf
    v_add_f32_dpp v19, v19, v19 quad_perm:[1,0,3,2] row_mask:0xf bank_mask:0xf
    v_add_f32_dpp v20, v20, v20 quad_perm:[1,0,3,2] row_mask:0xf bank_mask:0xf
    v_add_f32_dpp v21, v21, v21 quad_perm:[1,0,3,2] row_mask:0xf bank_mask:0xf
    v_add_f32_dpp v22, v22, v22 quad_perm:[1,0,3,2] row_mask:0xf bank_mask:0xf
    v_add_f32_dpp v23, v23, v23 quad_perm:[1,0,3,2] row_mask:0xf bank_mask:0xf
    v_add_f32_dpp v16, v16, v16 quad_perm:[2,3,0,1] row_mask:0xf bank_mask:0xf
    v_add_f32_dpp v17, v17, v17 quad_perm:[2,3,0,1] row_mask:0xf bank_mask:0xf
    v_add_f32_dpp v18, v18, v18 quad_perm:[2,3,0,1] row_mask:0xf bank_mask:0xf
    v_add_f32_dpp v19, v19, v19 quad_perm:[2,3,0,1] row_mask:0xf bank_mask:0xf
    v_add_f32_dpp v20, v20, v20 quad_perm:[2,3,0,1] row_mask:0xf bank_mask:0xf
    v_add_f32_dpp v21, v21, v21 quad_perm:[2,3,0,1] row_mask:0xf bank_mask:0xf
    v_add_f32_dpp v22, v22, v22 quad_perm:[2,3,0,1] row_mask:0xf bank_mask:0xf
    v_add_f32_dpp v23, v23, v23 quad_perm:[2,3,0,1] row_mask:0xf bank_mask:0xf
    v_add_f32_dpp v16, v16, v16 row_half_mirror row_mask:0xf bank_mask:0xf
    v_add_f32_dpp v17, v17, v17 row_half_mirror row_mask:0xf bank_mask:0xf
    v_add_f32_dpp v18, v18, v18 row_half_mirror row_mask:0xf bank_mask:0xf
    v_add_f32_dpp v19, v19, v19 row_half_mirror row_mask:0xf bank_mask:0xf
    v_add_f32_dpp v20, v20, v20 row_half_mirror row_mask:0xf bank_mask:0xf
    v_add_f32_dpp v21, v21, v21 row_half_mirror row_mask:0xf bank_mask:0xf
    v_add_f32_dpp v22, v22, v22 row_half_mirror row_mask:0xf bank_mask:0xf
    v_add_f32_dpp v23, v23, v23 row_half_mirror row_mask:0xf bank_mask:0xf
    ds_write_b128 v26, v[16:19]
    ds_write_b128 v27, v[20:23]
    s_waitcnt lgkmcnt(0)
    s_barrier
    s_branch L_xchk
L_skip_18:
    buffer_load_dwordx4 v[44:47], v1, s[4:7], s90 offen offset:0 sc1
    buffer_load_dwordx4 v[48:51], v1, s[4:7], s90 offen offset:1024 sc1
    s_waitcnt vmcnt(0)
L_xchk:
    v_xor_b32 v12, v44, v45
    v_xor_b32 v13, v44, v46
    v_xor_b32 v14, v44, v47
    v_xor_b32 v15, s54, v44
    v_or3_b32 v12, v12, v13, v14
    v_xor_b32 v13, v44, v48
    v_xor_b32 v14, v44, v49
    v_or3_b32 v15, v15, v13, v14
    v_xor_b32 v13, v44, v50
    v_xor_b32 v14, v44, v51
    v_or3_b32 v12, v12, v13, v14
    v_bitop3_b32 v12, v12, v15, 3 bitop3:0xa8
    v_cmp_ne_u32 vcc, 0, v12
    s_cbranch_vccnz L_rt_19
L_bk_20:
    s_add_u32 s80, s89, 0
    buffer_load_dwordx4 v[64:67], v1, s[4:7], s80 offen offset:0 sc1
    buffer_load_dwordx4 v[68:71], v1, s[4:7], s80 offen offset:1024 sc1
    buffer_load_dwordx4 v[72:75], v1, s[4:7], s80 offen offset:2048 sc1
    buffer_load_dwordx4 v[76:79], v1, s[4:7], s80 offen offset:3072 sc1
    s_add_u32 s80, s89, 4096
    buffer_load_dwordx4 v[80:83], v1, s[4:7], s80 offen offset:0 sc1
    buffer_load_dwordx4 v[84:87], v1, s[4:7], s80 offen offset:1024 sc1
    ds_read_b128 v[128:131], v1 offset:0
    ds_read_b128 v[132:135], v1 offset:1024
    ds_read_b128 v[136:139], v1 offset:2048
    ds_read_b128 v[140:143], v1 offset:3072
    ds_read_b128 v[144:147], v1 offset:4096
    ds_read_b128 v[148:151], v1 offset:5120
    ds_read_b128 v[152:155], v1 offset:6144
    s_waitcnt vmcnt(5) lgkmcnt(5)
    v_mfma_f32_16x16x32_bf16 v[16:19], v[128:131], v[64:67], 0
    ds_read_b128 v[156:159], v1 offset:7168
    buffer_load_dwordx4 v[88:91], v1, s[4:7], s80 offen offset:2048 sc1
    v_mfma_f32_16x16x32_bf16 v[20:23], v[132:135], v[64:67], 0
    s_waitcnt lgkmcnt(4)
    ds_read_b128 v[128:131], v1 offset:8192
    v_mov_b32 v56, 0xbdd2d3e8
    v_mfma_f32_16x16x32_bf16 v[24:27], v[136:139], v[64:67], 0
    ds_read_b128 v[132:135], v1 offset:9216
    v_mov_b32 v57, 0xc0135761
    v_mfma_f32_16x16x32_bf16 v[28:31], v[140:143], v[64:67], 0
    s_waitcnt lgkmcnt(4)
    ds_read_b128 v[136:139], v1 offset:10240
    v_mov_b32 v58, 0
    v_mfma_f32_16x16x32_bf16 v[32:35], v[144:147], v[64:67], 0
    ds_read_b128 v[140:143], v1 offset:11264
    v_mov_b32 v59, 0
    v_mfma_f32_16x16x32_bf16 v[36:39], v[148:151], v[64:67], 0
    s_waitcnt lgkmcnt(4)
    ds_read_b128 v[144:147], v1 offset:12288
    buffer_load_dwordx4 v[92:95], v1, s[4:7], s80 offen offset:3072 sc1
    v_mfma_f32_16x16x32_bf16 v[40:43], v[152:155], v[64:67], 0
    s_waitcnt vmcnt(6) lgkmcnt(4)
    ds_read_b128 v[148:151], v1 offset:13312
    v_mov_b32 v60, 0
    v_mfma_f32_16x16x32_bf16 v[16:19], v[156:159], v[68:71], v[16:19]
    s_waitcnt lgkmcnt(4)
    ds_read_b128 v[152:155], v1 offset:14336
    v_mov_b32 v61, 0
    v_mfma_f32_16x16x32_bf16 v[20:23], v[128:131], v[68:71], v[20:23]
    ds_read_b128 v[156:159], v1 offset:15360
    ds_read_b128 v[188:191], v234 offset:448
    v_mfma_f32_16x16x32_bf16 v[24:27], v[132:135], v[68:71], v[24:27]
    s_waitcnt lgkmcnt(5)
    ds_read_b128 v[128:131], v1 offset:16384
    v_mfma_f32_16x16x32_bf16 v[28:31], v[136:139], v[68:71], v[28:31]
    s_add_u32 s80, s89, 8192
    ds_read_b128 v[132:135], v1 offset:17408
    buffer_load_dwordx4 v[96:99], v1, s[4:7], s80 offen offset:0 sc1
    v_mfma_f32_16x16x32_bf16 v[32:35], v[140:143], v[68:71], v[32:35]
    s_waitcnt lgkmcnt(5)
    ds_read_b128 v[136:139], v1 offset:18432
    ds_read_b128 v[192:195], v234 offset:512
    v_mfma_f32_16x16x32_bf16 v[36:39], v[144:147], v[68:71], v[36:39]
    ds_read_b128 v[140:143], v1 offset:19456
    ds_read_b128 v[196:199], v234 offset:576
    v_mfma_f32_16x16x32_bf16 v[40:43], v[148:151], v[68:71], v[40:43]
    s_waitcnt vmcnt(6) lgkmcnt(7)
    ds_read_b128 v[144:147], v1 offset:20480
    v_mfma_f32_16x16x32_bf16 v[16:19], v[152:155], v[72:75], v[16:19]
    s_barrier
    ds_read_b128 v[148:151], v1 offset:21504
    ds_read_b128 v[200:203], v234 offset:640
    v_mfma_f32_16x16x32_bf16 v[20:23], v[156:159], v[72:75], v[20:23]
    s_waitcnt lgkmcnt(7)
    ds_read_b128 v[152:155], v1 offset:22528
    buffer_load_dwordx4 v[100:103], v1, s[4:7], s80 offen offset:1024 sc1
    v_mfma_f32_16x16x32_bf16 v[24:27], v[128:131], v[72:75], v[24:27]
    ds_read_b128 v[156:159], v1 offset:23552
    ds_read_b128 v[204:207], v234 offset:704
    v_mfma_f32_16x16x32_bf16 v[28:31], v[132:135], v[72:75], v[28:31]
    s_waitcnt lgkmcnt(7)
    ds_read_b128 v[128:131], v1 offset:24576
    v_mfma_f32_16x16x32_bf16 v[32:35], v[136:139], v[72:75], v[32:35]
    ds_read_b128 v[132:135], v1 offset:25600
    ds_read_b128 v[208:211], v234 offset:768
    v_mfma_f32_16x16x32_bf16 v[36:39], v[140:143], v[72:75], v[36:39]
    s_waitcnt lgkmcnt(7)
    ds_read_b128 v[136:139], v1 offset:26624
    v_mfma_f32_16x16x32_bf16 v[40:43], v[144:147], v[72:75], v[40:43]
    s_waitcnt vmcnt(6) lgkmcnt(6)
    ds_read_b128 v[140:143], v1 offset:27648
    buffer_load_dwordx4 v[104:107], v1, s[4:7], s80 offen offset:2048 sc1
    v_mfma_f32_16x16x32_bf16 v[16:19], v[148:151], v[76:79], v[16:19]
    s_waitcnt lgkmcnt(6)
    ds_read_b128 v[144:147], v1 offset:28672
    ds_read_b128 v[212:215], v234 offset:832
    v_mfma_f32_16x16x32_bf16 v[20:23], v[152:155], v[76:79], v[20:23]
    ds_read_b128 v[148:151], v1 offset:29696
    v_add_f32 v44, v44, v46
    v_mfma_f32_16x16x32_bf16 v[24:27], v[156:159], v[76:79], v[24:27]
    s_waitcnt lgkmcnt(6)
    ds_read_b128 v[152:155], v1 offset:30720
    v_add_f32 v45, v45, v47
    v_mfma_f32_16x16x32_bf16 v[28:31], v[128:131], v[76:79], v[28:31]
    ds_read_b128 v[156:159], v1 offset:31744
    v_add_f32 v48, v48, v50
    v_mfma_f32_16x16x32_bf16 v[32:35], v[132:135], v[76:79], v[32:35]
    s_waitcnt lgkmcnt(5)
    ds_read_b128 v[128:131], v1 offset:32768
    buffer_load_dwordx4 v[108:111], v1, s[4:7], s80 offen offset:3072 sc1
    v_mfma_f32_16x16x32_bf16 v[36:39], v[136:139], v[76:79], v[36:39]
    ds_read_b128 v[132:135], v1 offset:33792
    v_add_f32 v49, v49, v51
    v_mfma_f32_16x16x32_bf16 v[40:43], v[140:143], v[76:79], v[40:43]
    s_waitcnt vmcnt(7) lgkmcnt(4)
    ds_read_b128 v[136:139], v1 offset:34816
    v_add_f32 v54, v44, v48
    v_mfma_f32_16x16x32_bf16 v[16:19], v[144:147], v[80:83], v[16:19]
    ds_read_b128 v[140:143], v1 offset:35840
    v_add_f32 v55, v45, v49
    v_mfma_f32_16x16x32_bf16 v[20:23], v[148:151], v[80:83], v[20:23]
    s_waitcnt lgkmcnt(4)
    ds_read_b128 v[144:147], v1 offset:36864
    v_permlane32_swap_b32 v54, v55
    v_mfma_f32_16x16x32_bf16 v[24:27], v[152:155], v[80:83], v[24:27]
    s_add_u32 s80, s89, 12288
    ds_read_b128 v[148:151], v1 offset:37888
    buffer_load_dwordx4 v[112:115], v1, s[4:7], s80 offen offset:0 sc1
    v_mfma_f32_16x16x32_bf16 v[28:31], v[156:159], v[80:83], v[28:31]
    s_waitcnt lgkmcnt(4)
    ds_read_b128 v[152:155], v1 offset:38912
    v_add_f32 v54, v54, v55
    v_mfma_f32_16x16x32_bf16 v[32:35], v[128:131], v[80:83], v[32:35]
    ds_read_b128 v[156:159], v1 offset:39936
    v_mov_b32 v55, v54
    v_mfma_f32_16x16x32_bf16 v[36:39], v[132:135], v[80:83], v[36:39]
    s_waitcnt lgkmcnt(4)
    ds_read_b128 v[128:131], v1 offset:40960
    v_permlane16_swap_b32 v54, v55
    v_mfma_f32_16x16x32_bf16 v[40:43], v[136:139], v[80:83], v[40:43]
    s_waitcnt vmcnt(7) lgkmcnt(4)
    ds_read_b128 v[132:135], v1 offset:41984
    v_add_f32 v54, v54, v55
    v_mfma_f32_16x16x32_bf16 v[16:19], v[140:143], v[84:87], v[16:19]
    s_waitcnt lgkmcnt(4)
    ds_read_b128 v[136:139], v1 offset:43008
    buffer_load_dwordx4 v[116:119], v1, s[4:7], s80 offen offset:1024 sc1
    v_mfma_f32_16x16x32_bf16 v[20:23], v[144:147], v[84:87], v[20:23]
    ds_read_b128 v[140:143], v1 offset:44032
    v_mov_b32 v55, v54
    v_mfma_f32_16x16x32_bf16 v[24:27], v[148:151], v[84:87], v[24:27]
    s_waitcnt lgkmcnt(4)
    ds_read_b128 v[144:147], v1 offset:45056
    v_permlane32_swap_b32 v54, v55
    v_mfma_f32_16x16x32_bf16 v[28:31], v[152:155], v[84:87], v[28:31]
    ds_read_b128 v[148:151], v1 offset:46080
    v_mul_f32 v54, 0x3b000000, v54
    v_mfma_f32_16x16x32_bf16 v[32:35], v[156:159], v[84:87], v[32:35]
    s_waitcnt lgkmcnt(4)
    ds_read_b128 v[152:155], v1 offset:47104
    v_mul_f32 v55, 0x3b000000, v55
    v_mfma_f32_16x16x32_bf16 v[36:39], v[128:131], v[84:87], v[36:39]
    ds_read_b128 v[156:159], v1 offset:48128
    buffer_load_dwordx4 v[120:123], v1, s[4:7], s80 offen offset:2048 sc1
    v_mfma_f32_16x16x32_bf16 v[40:43], v[132:135], v[84:87], v[40:43]
    s_waitcnt vmcnt(8) lgkmcnt(4)
    ds_read_b128 v[128:131], v1 offset:49152
    v_fma_f32 v55, -v54, v54, v55
    v_mfma_f32_16x16x32_bf16 v[16:19], v[136:139], v[88:91], v[16:19]
    ds_read_b128 v[132:135], v1 offset:50176
    v_max_f32 v55, 0, v55
    v_mfma_f32_16x16x32_bf16 v[20:23], v[140:143], v[88:91], v[20:23]
    s_waitcnt lgkmcnt(4)
    ds_read_b128 v[136:139], v1 offset:51200
    v_add_f32 v55, 0x3727c5ac, v55
    v_mfma_f32_16x16x32_bf16 v[24:27], v[144:147], v[88:91], v[24:27]
    ds_read_b128 v[140:143], v1 offset:52224
    v_rsq_f32 v52, v55
    v_mfma_f32_16x16x32_bf16 v[28:31], v[148:151], v[88:91], v[28:31]
    s_waitcnt lgkmcnt(4)
    ds_read_b128 v[144:147], v1 offset:53248
    buffer_load_dwordx4 v[124:127], v1, s[4:7], s80 offen offset:3072 sc1
    v_mfma_f32_16x16x32_bf16 v[32:35], v[152:155], v[88:91], v[32:35]
    ds_read_b128 v[148:151], v1 offset:54272
    v_mul_f32 v53, -v54, v52
    v_mfma_f32_16x16x32_bf16 v[36:39], v[156:159], v[88:91], v[36:39]
    s_waitcnt lgkmcnt(4)
    ds_read_b128 v[152:155], v1 offset:55296
    v_mul_f32 v188, v188, v53
    v_mfma_f32_16x16x32_bf16 v[40:43], v[128:131], v[88:91], v[40:43]
    s_waitcnt vmcnt(8) lgkmcnt(4)
    ds_read_b128 v[156:159], v1 offset:56320
    v_mul_f32 v189, v189, v53
    v_mfma_f32_16x16x32_bf16 v[16:19], v[132:135], v[92:95], v[16:19]
    s_waitcnt lgkmcnt(4)
    ds_read_b128 v[128:131], v6 offset:0
    v_mul_f32 v190, v190, v53
    v_mfma_f32_16x16x32_bf16 v[20:23], v[136:139], v[92:95], v[20:23]
    ds_read_b128 v[132:135], v6 offset:1024
    buffer_load_dwordx4 v[160:163], v1, s[4:7], s41 offen sc1
    v_mfma_f32_16x16x32_bf16 v[24:27], v[140:143], v[92:95], v[24:27]
    s_waitcnt lgkmcnt(4)
    ds_read_b128 v[136:139], v6 offset:2048
    buffer_load_dwordx4 v[164:167], v1, s[4:7], s41 offen offset:1024 sc1
    v_mfma_f32_16x16x32_bf16 v[28:31], v[144:147], v[92:95], v[28:31]
    ds_read_b128 v[140:143], v6 offset:3072
    v_mul_f32 v191, v191, v53
    v_mfma_f32_16x16x32_bf16 v[32:35], v[148:151], v[92:95], v[32:35]
    s_waitcnt lgkmcnt(4)
    ds_read_b128 v[144:147], v6 offset:4096
    v_mul_f32 v192, v192, v53
    v_mfma_f32_16x16x32_bf16 v[36:39], v[152:155], v[92:95], v[36:39]
    ds_read_b128 v[148:151], v6 offset:5120
    v_mul_f32 v193, v193, v53
    v_mfma_f32_16x16x32_bf16 v[40:43], v[156:159], v[92:95], v[40:43]
    s_waitcnt vmcnt(9) lgkmcnt(4)
    ds_read_b128 v[152:155], v6 offset:6144
    v_mul_f32 v194, v194, v53
    v_mfma_f32_16x16x32_bf16 v[16:19], v[128:131], v[96:99], v[16:19]
    s_add_u32 s85, s88, 0x0
    s_barrier
    ds_read_b128 v[156:159], v6 offset:7168
    s_add_u32 m0, s69, 0x15000
    v_mfma_f32_16x16x32_bf16 v[20:23], v[132:135], v[96:99], v[20:23]
    s_waitcnt lgkmcnt(4)
    ds_read_b128 v[128:131], v6 offset:8192
    buffer_load_dwordx4 v1, s[4:7], s85 offen offset:0 sc1 lds
    v_mfma_f32_16x16x32_bf16 v[24:27], v[136:139], v[96:99], v[24:27]
    ds_read_b128 v[132:135], v6 offset:9216
    v_mul_f32 v195, v195, v53
    v_mfma_f32_16x16x32_bf16 v[28:31], v[140:143], v[96:99], v[28:31]
    s_waitcnt lgkmcnt(4)
    ds_read_b128 v[136:139], v6 offset:10240
    v_mul_f32 v196, v196, v53
    v_mfma_f32_16x16x32_bf16 v[32:35], v[144:147], v[96:99], v[32:35]
    ds_read_b128 v[140:143], v6 offset:11264
    buffer_load_dwordx4 v1, s[4:7], s85 offen offset:1024 sc1 lds
    v_mfma_f32_16x16x32_bf16 v[36:39], v[148:151], v[96:99], v[36:39]
    s_waitcnt lgkmcnt(4)
    ds_read_b128 v[144:147], v6 offset:12288
    v_mul_f32 v197, v197, v53
    v_mfma_f32_16x16x32_bf16 v[40:43], v[152:155], v[96:99], v[40:43]
    s_waitcnt vmcnt(10) lgkmcnt(4)
    ds_read_b128 v[148:151], v6 offset:13312
    v_mul_f32 v198, v198, v53
    v_mfma_f32_16x16x32_bf16 v[16:19], v[156:159], v[100:103], v[16:19]
    s_waitcnt lgkmcnt(4)
    ds_read_b128 v[152:155], v6 offset:14336
    v_mul_f32 v199, v199, v53
    v_mfma_f32_16x16x32_bf16 v[20:23], v[128:131], v[100:103], v[20:23]
    ds_read_b128 v[156:159], v6 offset:15360
    buffer_load_dwordx4 v1, s[4:7], s85 offen offset:2048 sc1 lds
    v_mfma_f32_16x16x32_bf16 v[24:27], v[132:135], v[100:103], v[24:27]
    s_waitcnt lgkmcnt(4)
    ds_read_b128 v[128:131], v6 offset:16384
    v_mul_f32 v200, v200, v53
    v_mfma_f32_16x16x32_bf16 v[28:31], v[136:139], v[100:103], v[28:31]
    ds_read_b128 v[132:135], v6 offset:17408
    v_mul_f32 v201, v201, v53
    v_mfma_f32_16x16x32_bf16 v[32:35], v[140:143], v[100:103], v[32:35]
    s_waitcnt lgkmcnt(4)
    ds_read_b128 v[136:139], v6 offset:18432
    v_mul_f32 v202, v202, v53
    v_mfma_f32_16x16x32_bf16 v[36:39], v[144:147], v[100:103], v[36:39]
    ds_read_b128 v[140:143], v6 offset:19456
    buffer_load_dwordx4 v1, s[4:7], s85 offen offset:3072 sc1 lds
    v_mfma_f32_16x16x32_bf16 v[40:43], v[148:151], v[100:103], v[40:43]
    s_waitcnt vmcnt(11) lgkmcnt(4)
    ds_read_b128 v[144:147], v6 offset:20480
    v_mul_f32 v203, v203, v53
    v_mfma_f32_16x16x32_bf16 v[16:19], v[152:155], v[104:107], v[16:19]
    ds_read_b128 v[148:151], v6 offset:21504
    v_mul_f32 v204, v204, v53
    v_mfma_f32_16x16x32_bf16 v[20:23], v[156:159], v[104:107], v[20:23]
    s_waitcnt lgkmcnt(4)
    ds_read_b128 v[152:155], v6 offset:22528
    v_mul_f32 v205, v205, v53
    v_mfma_f32_16x16x32_bf16 v[24:27], v[128:131], v[104:107], v[24:27]
    s_add_u32 s85, s88, 0x1000
    ds_read_b128 v[156:159], v6 offset:23552
    s_add_u32 m0, s69, 0x16000
    v_mfma_f32_16x16x32_bf16 v[28:31], v[132:135], v[104:107], v[28:31]
    s_waitcnt lgkmcnt(4)
    ds_read_b128 v[128:131], v6 offset:24576
    buffer_load_dwordx4 v1, s[4:7], s85 offen offset:0 sc1 lds
    v_mfma_f32_16x16x32_bf16 v[32:35], v[136:139], v[104:107], v[32:35]
    ds_read_b128 v[132:135], v6 offset:25600
    v_mul_f32 v206, v206, v53
    v_mfma_f32_16x16x32_bf16 v[36:39], v[140:143], v[104:107], v[36:39]
    s_waitcnt lgkmcnt(4)
    ds_read_b128 v[136:139], v6 offset:26624
    v_mul_f32 v207, v207, v53
    v_mfma_f32_16x16x32_bf16 v[40:43], v[144:147], v[104:107], v[40:43]
    s_waitcnt vmcnt(11) lgkmcnt(4)
    ds_read_b128 v[140:143], v6 offset:27648
    buffer_load_dwordx4 v1, s[4:7], s85 offen offset:1024 sc1 lds
    v_mfma_f32_16x16x32_bf16 v[16:19], v[148:151], v[108:111], v[16:19]
    s_waitcnt lgkmcnt(4)
    ds_read_b128 v[144:147], v5 offset:0
    v_mul_f32 v208, v208, v53
    v_mfma_f32_16x16x32_bf16 v[20:23], v[152:155], v[108:111], v[20:23]
    ds_read_b128 v[148:151], v5 offset:1024
    v_mul_f32 v209, v209, v53
    v_mfma_f32_16x16x32_bf16 v[24:27], v[156:159], v[108:111], v[24:27]
    s_waitcnt lgkmcnt(4)
    ds_read_b128 v[152:155], v5 offset:2048
    v_mul_f32 v210, v210, v53
    v_mfma_f32_16x16x32_bf16 v[28:31], v[128:131], v[108:111], v[28:31]
    ds_read_b128 v[156:159], v5 offset:3072
    buffer_load_dwordx4 v1, s[4:7], s85 offen offset:2048 sc1 lds
    v_mfma_f32_16x16x32_bf16 v[32:35], v[132:135], v[108:111], v[32:35]
    s_waitcnt lgkmcnt(4)
    ds_read_b128 v[128:131], v5 offset:4096
    v_mul_f32 v211, v211, v53
    v_mfma_f32_16x16x32_bf16 v[36:39], v[136:139], v[108:111], v[36:39]
    ds_read_b128 v[132:135], v5 offset:5120
    v_mul_f32 v212, v212, v53
    v_mfma_f32_16x16x32_bf16 v[40:43], v[140:143], v[108:111], v[40:43]
    s_waitcnt vmcnt(12) lgkmcnt(4)
    ds_read_b128 v[136:139], v5 offset:6144
    v_mul_f32 v213, v213, v53
    v_mfma_f32_16x16x32_bf16 v[16:19], v[144:147], v[112:115], v[16:19]
    s_add_u32 s85, s88, 0x7000
    ds_read_b128 v[140:143], v5 offset:7168
    s_add_u32 m0, s69, 0x0
    v_mfma_f32_16x16x32_bf16 v[20:23], v[148:151], v[112:115], v[20:23]
    s_waitcnt lgkmcnt(4)
    ds_read_b128 v[144:147], v5 offset:8192
    buffer_load_dwordx4 v1, s[4:7], s85 offen offset:0 sc1 lds
    v_mfma_f32_16x16x32_bf16 v[24:27], v[152:155], v[112:115], v[24:27]
    ds_read_b128 v[148:151], v5 offset:9216
    v_mul_f32 v214, v214, v53
    v_mfma_f32_16x16x32_bf16 v[28:31], v[156:159], v[112:115], v[28:31]
    s_waitcnt lgkmcnt(4)
    ds_read_b128 v[152:155], v5 offset:10240
    v_mul_f32 v215, v215, v53
    v_mfma_f32_16x16x32_bf16 v[32:35], v[128:131], v[112:115], v[32:35]
    ds_read_b128 v[156:159], v5 offset:11264
    buffer_load_dwordx4 v1, s[4:7], s85 offen offset:1024 sc1 lds
    v_mfma_f32_16x16x32_bf16 v[36:39], v[132:135], v[112:115], v[36:39]
    s_waitcnt lgkmcnt(4)
    ds_read_b128 v[128:131], v5 offset:12288
    v_mfma_f32_16x16x32_bf16 v[40:43], v[136:139], v[112:115], v[40:43]
    s_waitcnt vmcnt(13) lgkmcnt(4)
    ds_read_b128 v[132:135], v5 offset:13312
    v_mfma_f32_16x16x32_bf16 v[16:19], v[140:143], v[116:119], v[16:19]
    s_waitcnt lgkmcnt(4)
    ds_read_b128 v[136:139], v5 offset:14336
    v_mfma_f32_16x16x32_bf16 v[20:23], v[144:147], v[116:119], v[20:23]
    ds_read_b128 v[140:143], v5 offset:15360
    buffer_load_dwordx4 v1, s[4:7], s85 offen offset:2048 sc1 lds
    v_mfma_f32_16x16x32_bf16 v[24:27], v[148:151], v[116:119], v[24:27]
    s_waitcnt lgkmcnt(4)
    ds_read_b128 v[144:147], v5 offset:16384
    v_mfma_f32_16x16x32_bf16 v[28:31], v[152:155], v[116:119], v[28:31]
    ds_read_b128 v[148:151], v5 offset:17408
    v_mfma_f32_16x16x32_bf16 v[32:35], v[156:159], v[116:119], v[32:35]
    s_waitcnt lgkmcnt(4)
    ds_read_b128 v[152:155], v5 offset:18432
    v_mfma_f32_16x16x32_bf16 v[36:39], v[128:131], v[116:119], v[36:39]
    ds_read_b128 v[156:159], v5 offset:19456
    buffer_load_dwordx4 v1, s[4:7], s85 offen offset:3072 sc1 lds
    v_mfma_f32_16x16x32_bf16 v[40:43], v[132:135], v[116:119], v[40:43]
    s_waitcnt vmcnt(14) lgkmcnt(4)
    ds_read_b128 v[128:131], v5 offset:20480
    v_mfma_f32_16x16x32_bf16 v[16:19], v[136:139], v[120:123], v[16:19]
    ds_read_b128 v[132:135], v5 offset:21504
    v_mfma_f32_16x16x32_bf16 v[20:23], v[140:143], v[120:123], v[20:23]
    s_waitcnt lgkmcnt(4)
    ds_read_b128 v[136:139], v5 offset:22528
    v_mfma_f32_16x16x32_bf16 v[24:27], v[144:147], v[120:123], v[24:27]
    s_add_u32 s85, s88, 0x8000
    ds_read_b128 v[140:143], v5 offset:23552
    s_add_u32 m0, s69, 0x1000
    v_mfma_f32_16x16x32_bf16 v[28:31], v[148:151], v[120:123], v[28:31]
    s_waitcnt lgkmcnt(4)
    ds_read_b128 v[144:147], v5 offset:24576
    buffer_load_dwordx4 v1, s[4:7], s85 offen offset:0 sc1 lds
    v_mfma_f32_16x16x32_bf16 v[32:35], v[152:155], v[120:123], v[32:35]
    ds_read_b128 v[148:151], v5 offset:25600
    v_mfma_f32_16x16x32_bf16 v[36:39], v[156:159], v[120:123], v[36:39]
    s_waitcnt lgkmcnt(4)
    ds_read_b128 v[152:155], v5 offset:26624
    v_mfma_f32_16x16x32_bf16 v[40:43], v[128:131], v[120:123], v[40:43]
    s_waitcnt vmcnt(14) lgkmcnt(4)
    ds_read_b128 v[156:159], v5 offset:27648
    buffer_load_dwordx4 v1, s[4:7], s85 offen offset:1024 sc1 lds
    v_mfma_f32_16x16x32_bf16 v[16:19], v[132:135], v[124:127], v[16:19]
    s_waitcnt lgkmcnt(4)
    v_mfma_f32_16x16x32_bf16 v[20:23], v[136:139], v[124:127], v[20:23]
    v_mfma_f32_16x16x32_bf16 v[24:27], v[140:143], v[124:127], v[24:27]
    s_waitcnt lgkmcnt(2)
    v_mfma_f32_16x16x32_bf16 v[28:31], v[144:147], v[124:127], v[28:31]
    buffer_load_dwordx4 v1, s[4:7], s85 offen offset:2048 sc1 lds
    v_mfma_f32_16x16x32_bf16 v[32:35], v[148:151], v[124:127], v[32:35]
    s_waitcnt lgkmcnt(0)
    v_mfma_f32_16x16x32_bf16 v[36:39], v[152:155], v[124:127], v[36:39]
    v_mfma_f32_16x16x32_bf16 v[40:43], v[156:159], v[124:127], v[40:43]
    s_barrier
    v_pk_fma_f32 v[16:17], v[16:17], v[52:53], v[188:189] op_sel_hi:[1,0,1]
    v_pk_mul_f32 v[216:217], v[16:17], v[16:17]
    v_pk_fma_f32 v[216:217], v[216:217], v[56:57], v[56:57] op_sel:[0,0,1] op_sel_hi:[1,0,1]
    v_pk_mul_f32 v[216:217], v[216:217], v[16:17]
    v_exp_f32 v216, v216
    v_exp_f32 v217, v217
    s_add_u32 s85, s88, 0xe000
    s_add_u32 m0, s69, 0x7000
    s_nop 0
    buffer_load_dwordx4 v1, s[4:7], s85 offen offset:0 sc1 lds
    v_pk_fma_f32 v[18:19], v[18:19], v[52:53], v[190:191] op_sel_hi:[1,0,1]
    v_pk_mul_f32 v[218:219], v[18:19], v[18:19]
    v_pk_fma_f32 v[218:219], v[218:219], v[56:57], v[56:57] op_sel:[0,0,1] op_sel_hi:[1,0,1]
    v_pk_mul_f32 v[218:219], v[218:219], v[18:19]
    v_exp_f32 v218, v218
    v_exp_f32 v219, v219
    v_pk_add_f32 v[216:217], v[216:217], 1.0 op_sel_hi:[1,0]
    v_rcp_f32 v216, v216
    v_rcp_f32 v217, v217
    buffer_load_dwordx4 v1, s[4:7], s85 offen offset:1024 sc1 lds
    v_pk_fma_f32 v[20:21], v[20:21], v[52:53], v[192:193] op_sel_hi:[1,0,1]
    v_pk_mul_f32 v[220:221], v[20:21], v[20:21]
    v_pk_fma_f32 v[220:221], v[220:221], v[56:57], v[56:57] op_sel:[0,0,1] op_sel_hi:[1,0,1]
    v_pk_mul_f32 v[220:221], v[220:221], v[20:21]
    v_exp_f32 v220, v220
    v_exp_f32 v221, v221
    v_pk_add_f32 v[218:219], v[218:219], 1.0 op_sel_hi:[1,0]
    v_rcp_f32 v218, v218
    v_rcp_f32 v219, v219
    v_pk_mul_f32 v[16:17], v[16:17], v[216:217]
    v_pk_fma_f32 v[60:61], v[16:17], v[16:17], v[60:61]
    v_pk_add_f32 v[58:59], v[58:59], v[16:17]
    buffer_load_dwordx4 v1, s[4:7], s85 offen offset:2048 sc1 lds
    v_pk_fma_f32 v[22:23], v[22:23], v[52:53], v[194:195] op_sel_hi:[1,0,1]
    v_pk_mul_f32 v[216:217], v[22:23], v[22:23]
    v_pk_fma_f32 v[216:217], v[216:217], v[56:57], v[56:57] op_sel:[0,0,1] op_sel_hi:[1,0,1]
    v_pk_mul_f32 v[216:217], v[216:217], v[22:23]
    v_exp_f32 v216, v216
    v_exp_f32 v217, v217
    v_pk_add_f32 v[220:221], v[220:221], 1.0 op_sel_hi:[1,0]
    v_rcp_f32 v220, v220
    v_rcp_f32 v221, v221
    v_pk_mul_f32 v[18:19], v[18:19], v[218:219]
    v_pk_fma_f32 v[60:61], v[18:19], v[18:19], v[60:61]
    v_pk_add_f32 v[58:59], v[58:59], v[18:19]
    buffer_load_dwordx4 v1, s[4:7], s85 offen offset:3072 sc1 lds
    v_pk_fma_f32 v[24:25], v[24:25], v[52:53], v[196:197] op_sel_hi:[1,0,1]
    v_pk_mul_f32 v[218:219], v[24:25], v[24:25]
    v_pk_fma_f32 v[218:219], v[218:219], v[56:57], v[56:57] op_sel:[0,0,1] op_sel_hi:[1,0,1]
    v_pk_mul_f32 v[218:219], v[218:219], v[24:25]
    v_exp_f32 v218, v218
    v_exp_f32 v219, v219
    v_pk_add_f32 v[216:217], v[216:217], 1.0 op_sel_hi:[1,0]
    v_rcp_f32 v216, v216
    v_rcp_f32 v217, v217
    v_pk_mul_f32 v[20:21], v[20:21], v[220:221]
    v_pk_fma_f32 v[60:61], v[20:21], v[20:21], v[60:61]
    v_pk_add_f32 v[58:59], v[58:59], v[20:21]
    s_add_u32 s85, s88, 0xf000
    s_add_u32 m0, s69, 0x8000
    s_nop 0
    buffer_load_dwordx4 v1, s[4:7], s85 offen offset:0 sc1 lds
    v_pk_fma_f32 v[26:27], v[26:27], v[52:53], v[198:199] op_sel_hi:[1,0,1]
    v_pk_mul_f32 v[220:221], v[26:27], v[26:27]
    v_pk_fma_f32 v[220:221], v[220:221], v[56:57], v[56:57] op_sel:[0,0,1] op_sel_hi:[1,0,1]
    v_pk_mul_f32 v[220:221], v[220:221], v[26:27]
    v_exp_f32 v220, v220
    v_exp_f32 v221, v221
    v_pk_add_f32 v[218:219], v[218:219], 1.0 op_sel_hi:[1,0]
    v_rcp_f32 v218, v218
    v_rcp_f32 v219, v219
    v_pk_mul_f32 v[22:23], v[22:23], v[216:217]
    v_pk_fma_f32 v[60:61], v[22:23], v[22:23], v[60:61]
    v_pk_add_f32 v[58:59], v[58:59], v[22:23]
    buffer_load_dwordx4 v1, s[4:7], s85 offen offset:1024 sc1 lds
    v_pk_fma_f32 v[28:29], v[28:29], v[52:53], v[200:201] op_sel_hi:[1,0,1]
    v_pk_mul_f32 v[216:217], v[28:29], v[28:29]
    v_pk_fma_f32 v[216:217], v[216:217], v[56:57], v[56:57] op_sel:[0,0,1] op_sel_hi:[1,0,1]
    v_pk_mul_f32 v[216:217], v[216:217], v[28:29]
    v_exp_f32 v216, v216
    v_exp_f32 v217, v217
    v_pk_add_f32 v[220:221], v[220:221], 1.0 op_sel_hi:[1,0]
    v_rcp_f32 v220, v220
    v_rcp_f32 v221, v221
    v_pk_mul_f32 v[24:25], v[24:25], v[218:219]
    v_pk_fma_f32 v[60:61], v[24:25], v[24:25], v[60:61]
    v_pk_add_f32 v[58:59], v[58:59], v[24:25]
    buffer_load_dwordx4 v1, s[4:7], s85 offen offset:2048 sc1 lds
    v_pk_fma_f32 v[30:31], v[30:31], v[52:53], v[202:203] op_sel_hi:[1,0,1]
    v_pk_mul_f32 v[218:219], v[30:31], v[30:31]
    v_pk_fma_f32 v[218:219], v[218:219], v[56:57], v[56:57] op_sel:[0,0,1] op_sel_hi:[1,0,1]
    v_pk_mul_f32 v[218:219], v[218:219], v[30:31]
    v_exp_f32 v218, v218
    v_exp_f32 v219, v219
    v_pk_add_f32 v[216:217], v[216:217], 1.0 op_sel_hi:[1,0]
    v_rcp_f32 v216, v216
    v_rcp_f32 v217, v217
    v_pk_mul_f32 v[26:27], v[26:27], v[220:221]
    v_pk_fma_f32 v[60:61], v[26:27], v[26:27], v[60:61]
    v_pk_add_f32 v[58:59], v[58:59], v[26:27]
    s_add_u32 s85, s88, 0x15000
    s_add_u32 m0, s69, 0x1c000
    s_nop 0
    buffer_load_dwordx4 v1, s[4:7], s85 offen offset:0 sc1 lds
    v_pk_fma_f32 v[32:33], v[32:33], v[52:53], v[204:205] op_sel_hi:[1,0,1]
    v_pk_mul_f32 v[220:221], v[32:33], v[32:33]
    v_pk_fma_f32 v[220:221], v[220:221], v[56:57], v[56:57] op_sel:[0,0,1] op_sel_hi:[1,0,1]
    v_pk_mul_f32 v[220:221], v[220:221], v[32:33]
    v_exp_f32 v220, v220
    v_exp_f32 v221, v221
    v_pk_add_f32 v[218:219], v[218:219], 1.0 op_sel_hi:[1,0]
    v_rcp_f32 v218, v218
    v_rcp_f32 v219, v219
    v_pk_mul_f32 v[28:29], v[28:29], v[216:217]
    v_pk_fma_f32 v[60:61], v[28:29], v[28:29], v[60:61]
    v_pk_add_f32 v[58:59], v[58:59], v[28:29]
    buffer_load_dwordx4 v1, s[4:7], s85 offen offset:1024 sc1 lds
    v_pk_fma_f32 v[34:35], v[34:35], v[52:53], v[206:207] op_sel_hi:[1,0,1]
    v_pk_mul_f32 v[216:217], v[34:35], v[34:35]
    v_pk_fma_f32 v[216:217], v[216:217], v[56:57], v[56:57] op_sel:[0,0,1] op_sel_hi:[1,0,1]
    v_pk_mul_f32 v[216:217], v[216:217], v[34:35]
    v_exp_f32 v216, v216
    v_exp_f32 v217, v217
    v_pk_add_f32 v[220:221], v[220:221], 1.0 op_sel_hi:[1,0]
    v_rcp_f32 v220, v220
    v_rcp_f32 v221, v221
    v_pk_mul_f32 v[30:31], v[30:31], v[218:219]
    v_pk_fma_f32 v[60:61], v[30:31], v[30:31], v[60:61]
    v_pk_add_f32 v[58:59], v[58:59], v[30:31]
    v_pk_fma_f32 v[36:37], v[36:37], v[52:53], v[208:209] op_sel_hi:[1,0,1]
    v_pk_mul_f32 v[218:219], v[36:37], v[36:37]
    v_pk_fma_f32 v[218:219], v[218:219], v[56:57], v[56:57] op_sel:[0,0,1] op_sel_hi:[1,0,1]
    v_pk_mul_f32 v[218:219], v[218:219], v[36:37]
    v_exp_f32 v218, v218
    v_exp_f32 v219, v219
    v_pk_add_f32 v[216:217], v[216:217], 1.0 op_sel_hi:[1,0]
    v_rcp_f32 v216, v216
    v_rcp_f32 v217, v217
    v_pk_mul_f32 v[32:33], v[32:33], v[220:221]
    v_pk_fma_f32 v[60:61], v[32:33], v[32:33], v[60:61]
    v_pk_add_f32 v[58:59], v[58:59], v[32:33]
    v_pk_fma_f32 v[38:39], v[38:39], v[52:53], v[210:211] op_sel_hi:[1,0,1]
    v_pk_mul_f32 v[220:221], v[38:39], v[38:39]
    v_pk_fma_f32 v[220:221], v[220:221], v[56:57], v[56:57] op_sel:[0,0,1] op_sel_hi:[1,0,1]
    v_pk_mul_f32 v[220:221], v[220:221], v[38:39]
    v_exp_f32 v220, v220
    v_exp_f32 v221, v221
    v_pk_add_f32 v[218:219], v[218:219], 1.0 op_sel_hi:[1,0]
    v_rcp_f32 v218, v218
    v_rcp_f32 v219, v219
    v_pk_mul_f32 v[34:35], v[34:35], v[216:217]
    v_pk_fma_f32 v[60:61], v[34:35], v[34:35], v[60:61]
    v_pk_add_f32 v[58:59], v[58:59], v[34:35]
    v_pk_fma_f32 v[40:41], v[40:41], v[52:53], v[212:213] op_sel_hi:[1,0,1]
    v_pk_mul_f32 v[216:217], v[40:41], v[40:41]
    v_pk_fma_f32 v[216:217], v[216:217], v[56:57], v[56:57] op_sel:[0,0,1] op_sel_hi:[1,0,1]
    v_pk_mul_f32 v[216:217], v[216:217], v[40:41]
    v_exp_f32 v216, v216
    v_exp_f32 v217, v217
    v_pk_add_f32 v[220:221], v[220:221], 1.0 op_sel_hi:[1,0]
    v_rcp_f32 v220, v220
    v_rcp_f32 v221, v221
    v_pk_mul_f32 v[36:37], v[36:37], v[218:219]
    v_pk_fma_f32 v[60:61], v[36:37], v[36:37], v[60:61]
    v_pk_add_f32 v[58:59], v[58:59], v[36:37]
    v_pk_fma_f32 v[42:43], v[42:43], v[52:53], v[214:215] op_sel_hi:[1,0,1]
    v_pk_mul_f32 v[218:219], v[42:43], v[42:43]
    v_pk_fma_f32 v[218:219], v[218:219], v[56:57], v[56:57] op_sel:[0,0,1] op_sel_hi:[1,0,1]
    v_pk_mul_f32 v[218:219], v[218:219], v[42:43]
    v_exp_f32 v218, v218
    v_exp_f32 v219, v219
    v_pk_add_f32 v[216:217], v[216:217], 1.0 op_sel_hi:[1,0]
    v_rcp_f32 v216, v216
    v_rcp_f32 v217, v217
    v_pk_mul_f32 v[38:39], v[38:39], v[220:221]
    v_pk_fma_f32 v[60:61], v[38:39], v[38:39], v[60:61]
    v_pk_add_f32 v[58:59], v[58:59], v[38:39]
    v_pk_add_f32 v[218:219], v[218:219], 1.0 op_sel_hi:[1,0]
    v_rcp_f32 v218, v218
    v_rcp_f32 v219, v219
    v_pk_mul_f32 v[40:41], v[40:41], v[216:217]
    v_pk_fma_f32 v[60:61], v[40:41], v[40:41], v[60:61]
    v_pk_add_f32 v[58:59], v[58:59], v[40:41]
    v_pk_mul_f32 v[42:43], v[42:43], v[218:219]
    v_pk_fma_f32 v[60:61], v[42:43], v[42:43], v[60:61]
    v_pk_add_f32 v[58:59], v[58:59], v[42:43]
    v_add_f32 v58, v58, v59
    v_add_f32 v60, v60, v61
    s_nop 1
    v_permlane32_swap_b32 v58, v60
    v_add_f32 v58, v58, v60
    v_mov_b32 v60, v58
    s_nop 1
    v_permlane16_swap_b32 v58, v60
    v_add_f32 v58, v58, v60
    s_waitcnt vmcnt(23)
    buffer_store_dword v58, v231, s[4:7], s34 offen
    ds_read_b128 v[188:191], v234 offset:0
    ds_read_b128 v[192:195], v234 offset:64
    ds_read_b128 v[196:199], v234 offset:128
    ds_read_b128 v[200:203], v234 offset:192
    ds_read_b128 v[204:207], v234 offset:256
    ds_read_b128 v[208:211], v234 offset:320
    ds_read_b128 v[212:215], v234 offset:384
    s_add_u32 s78, s92, 16384
    s_add_u32 s79, s92, 32768
    s_add_u32 s80, s92, 49152
    s_waitcnt lgkmcnt(6)
    v_pk_mul_f32 v[188:189], v[188:189], v[52:53] op_sel:[0,1] op_sel_hi:[1,1]
    v_pk_mul_f32 v[190:191], v[190:191], v[52:53] op_sel:[0,1] op_sel_hi:[1,1]
    s_waitcnt lgkmcnt(5)
    v_pk_mul_f32 v[192:193], v[192:193], v[52:53] op_sel:[0,1] op_sel_hi:[1,1]
    v_pk_mul_f32 v[194:195], v[194:195], v[52:53] op_sel:[0,1] op_sel_hi:[1,1]
    s_waitcnt lgkmcnt(4)
    v_pk_mul_f32 v[196:197], v[196:197], v[52:53] op_sel:[0,1] op_sel_hi:[1,1]
    v_pk_mul_f32 v[198:199], v[198:199], v[52:53] op_sel:[0,1] op_sel_hi:[1,1]
    s_waitcnt lgkmcnt(3)
    v_pk_mul_f32 v[200:201], v[200:201], v[52:53] op_sel:[0,1] op_sel_hi:[1,1]
    buffer_load_dwordx4 v[44:47], v1, s[4:7], s34 offen sc1
    v_pk_mul_f32 v[202:203], v[202:203], v[52:53] op_sel:[0,1] op_sel_hi:[1,1]
    s_waitcnt lgkmcnt(2)
    v_pk_mul_f32 v[204:205], v[204:205], v[52:53] op_sel:[0,1] op_sel_hi:[1,1]
    v_pk_mul_f32 v[206:207], v[206:207], v[52:53] op_sel:[0,1] op_sel_hi:[1,1]
    s_waitcnt lgkmcnt(1)
    v_pk_mul_f32 v[208:209], v[208:209], v[52:53] op_sel:[0,1] op_sel_hi:[1,1]
    v_pk_mul_f32 v[210:211], v[210:211], v[52:53] op_sel:[0,1] op_sel_hi:[1,1]
    s_waitcnt lgkmcnt(0)
    v_pk_mul_f32 v[212:213], v[212:213], v[52:53] op_sel:[0,1] op_sel_hi:[1,1]
    v_pk_mul_f32 v[214:215], v[214:215], v[52:53] op_sel:[0,1] op_sel_hi:[1,1]
    s_waitcnt vmcnt(0)
    v_max3_u32 v12, v44, v45, v46
    v_max_u32 v12, v12, v47
    v_cmp_eq_u32 vcc, -1, v12
    s_cbranch_vccnz L_rt_21
L_bk_22:
    s_add_u32 s85, s88, 0x15000
    s_add_u32 m0, s69, 0x1c000
    s_nop 0
    buffer_load_dwordx4 v1, s[4:7], s85 offen offset:2048 sc1 lds
    v_add_f32 v58, v44, v46
    v_add_f32 v59, v45, v47
    s_nop 1
    v_permlane32_swap_b32 v58, v59
    v_add_f32 v58, v58, v59
    v_mov_b32 v59, v58
    s_nop 1
    v_permlane16_swap_b32 v58, v59
    v_add_f32 v58, v58, v59
    v_mov_b32 v59, v58
    s_nop 1
    v_permlane32_swap_b32 v58, v59
    v_mul_f32 v58, 0x3a924925, v58
    v_mul_f32 v59, 0x3a924925, v59
    v_fma_f32 v59, -v58, v58, v59
    v_max_f32 v59, 0, v59
    v_add_f32 v59, 0x3727c5ac, v59
    v_rsq_f32 v60, v59
    s_nop 0
    v_mul_f32 v61, -v58, v60
    v_pk_fma_f32 v[16:17], v[16:17], v[60:61], v[60:61] op_sel:[0,0,1] op_sel_hi:[1,0,1]
    v_pk_fma_f32 v[18:19], v[18:19], v[60:61], v[60:61] op_sel:[0,0,1] op_sel_hi:[1,0,1]
    v_cvt_pk_bf16_f32 v16, v16, v17
    v_cvt_pk_bf16_f32 v17, v18, v19
    ds_write_b64 v232, v[16:17] offset:0
    v_pk_fma_f32 v[20:21], v[20:21], v[60:61], v[60:61] op_sel:[0,0,1] op_sel_hi:[1,0,1]
    v_pk_fma_f32 v[22:23], v[22:23], v[60:61], v[60:61] op_sel:[0,0,1] op_sel_hi:[1,0,1]
    v_cvt_pk_bf16_f32 v20, v20, v21
    v_cvt_pk_bf16_f32 v21, v22, v23
    ds_write_b64 v232, v[20:21] offset:32
    buffer_load_dwordx4 v1, s[4:7], s85 offen offset:3072 sc1 lds
    v_pk_fma_f32 v[24:25], v[24:25], v[60:61], v[60:61] op_sel:[0,0,1] op_sel_hi:[1,0,1]
    v_pk_fma_f32 v[26:27], v[26:27], v[60:61], v[60:61] op_sel:[0,0,1] op_sel_hi:[1,0,1]
    v_cvt_pk_bf16_f32 v24, v24, v25
    v_cvt_pk_bf16_f32 v25, v26, v27
    ds_write_b64 v232, v[24:25] offset:64
    v_pk_fma_f32 v[28:29], v[28:29], v[60:61], v[60:61] op_sel:[0,0,1] op_sel_hi:[1,0,1]
    v_pk_fma_f32 v[30:31], v[30:31], v[60:61], v[60:61] op_sel:[0,0,1] op_sel_hi:[1,0,1]
    v_cvt_pk_bf16_f32 v28, v28, v29
    v_cvt_pk_bf16_f32 v29, v30, v31
    ds_write_b64 v232, v[28:29] offset:96
    s_add_u32 s85, s88, 0x16000
    s_add_u32 m0, s69, 0x1d000
    s_nop 0
    buffer_load_dwordx4 v1, s[4:7], s85 offen offset:0 sc1 lds
    v_pk_fma_f32 v[32:33], v[32:33], v[60:61], v[60:61] op_sel:[0,0,1] op_sel_hi:[1,0,1]
    v_pk_fma_f32 v[34:35], v[34:35], v[60:61], v[60:61] op_sel:[0,0,1] op_sel_hi:[1,0,1]
    v_cvt_pk_bf16_f32 v32, v32, v33
    v_cvt_pk_bf16_f32 v33, v34, v35
    ds_write_b64 v232, v[32:33] offset:128
    v_pk_fma_f32 v[36:37], v[36:37], v[60:61], v[60:61] op_sel:[0,0,1] op_sel_hi:[1,0,1]
    v_pk_fma_f32 v[38:39], v[38:39], v[60:61], v[60:61] op_sel:[0,0,1] op_sel_hi:[1,0,1]
    v_cvt_pk_bf16_f32 v36, v36, v37
    v_cvt_pk_bf16_f32 v37, v38, v39
    ds_write_b64 v232, v[36:37] offset:160
    buffer_load_dwordx4 v1, s[4:7], s85 offen offset:1024 sc1 lds
    v_pk_fma_f32 v[40:41], v[40:41], v[60:61], v[60:61] op_sel:[0,0,1] op_sel_hi:[1,0,1]
    v_pk_fma_f32 v[42:43], v[42:43], v[60:61], v[60:61] op_sel:[0,0,1] op_sel_hi:[1,0,1]
    v_cvt_pk_bf16_f32 v40, v40, v41
    v_cvt_pk_bf16_f32 v41, v42, v43
    ds_write_b64 v232, v[40:41] offset:192
    buffer_load_dwordx4 v1, s[4:7], s85 offen offset:2048 sc1 lds
    s_waitcnt lgkmcnt(0)
    s_barrier
    ds_read_b64_tr_b16 v[16:17], v233 offset:0
    ds_read_b64_tr_b16 v[18:19], v233 offset:240
    ds_read_b64_tr_b16 v[20:21], v233 offset:32
    ds_read_b64_tr_b16 v[22:23], v233 offset:272
    ds_read_b64_tr_b16 v[24:25], v233 offset:64
    ds_read_b64_tr_b16 v[26:27], v233 offset:304
    ds_read_b64_tr_b16 v[28:29], v233 offset:96
    ds_read_b64_tr_b16 v[30:31], v233 offset:336
    v_mov_b64 v[44:45], v[160:161]
    v_mov_b64 v[46:47], v[162:163]
    v_mov_b64 v[48:49], v[164:165]
    v_mov_b64 v[50:51], v[166:167]
    s_waitcnt lgkmcnt(6)
    buffer_store_dwordx4 v[16:19], v1, s[4:7], s92 offen sc1
    s_waitcnt lgkmcnt(4)
    buffer_store_dwordx4 v[20:23], v1, s[4:7], s78 offen sc1
    s_waitcnt lgkmcnt(2)
    buffer_store_dwordx4 v[24:27], v1, s[4:7], s79 offen sc1
    s_cmp_ge_u32 s62, 2
    s_cbranch_scc1 L_skip_23
    s_waitcnt lgkmcnt(0)
    buffer_store_dwordx4 v[28:31], v1, s[4:7], s80 offen sc1
L_skip_23:
    ds_read_b128 v[128:131], v5 offset:28672
    ds_read_b128 v[132:135], v5 offset:29696
    ds_read_b128 v[136:139], v5 offset:30720
    ds_read_b128 v[140:143], v5 offset:31744
    ds_read_b128 v[144:147], v5 offset:32768
    ds_read_b128 v[148:151], v5 offset:33792
    ds_read_b128 v[152:155], v5 offset:34816
    s_waitcnt lgkmcnt(5)
    v_mfma_f32_16x16x32_bf16 v[160:163], v[128:131], v[64:67], 0
    ds_read_b128 v[156:159], v5 offset:35840
    v_mfma_f32_16x16x32_bf16 v[164:167], v[132:135], v[64:67], 0
    s_waitcnt lgkmcnt(4)
    ds_read_b128 v[128:131], v5 offset:36864
    s_mul_i32 s78, s55, 0x101
    v_mfma_f32_16x16x32_bf16 v[168:171], v[136:139], v[64:67], 0
    ds_read_b128 v[132:135], v5 offset:37888
    v_mov_b32 v251, s78
    v_mfma_f32_16x16x32_bf16 v[172:175], v[140:143], v[64:67], 0
    s_waitcnt lgkmcnt(4)
    ds_read_b128 v[136:139], v5 offset:38912
    v_mfma_f32_16x16x32_bf16 v[176:179], v[144:147], v[64:67], 0
    ds_read_b128 v[140:143], v5 offset:39936
    v_mfma_f32_16x16x32_bf16 v[180:183], v[148:151], v[64:67], 0
    s_waitcnt lgkmcnt(4)
    ds_read_b128 v[144:147], v5 offset:40960
    v_mfma_f32_16x16x32_bf16 v[184:187], v[152:155], v[64:67], 0
    ds_read_b128 v[148:151], v5 offset:41984
    v_mfma_f32_16x16x32_bf16 v[160:163], v[156:159], v[68:71], v[160:163]
    s_waitcnt lgkmcnt(4)
    ds_read_b128 v[152:155], v5 offset:43008
    v_mfma_f32_16x16x32_bf16 v[164:167], v[128:131], v[68:71], v[164:167]
    ds_read_b128 v[156:159], v5 offset:44032
    v_mfma_f32_16x16x32_bf16 v[168:171], v[132:135], v[68:71], v[168:171]
    s_waitcnt lgkmcnt(4)
    ds_read_b128 v[128:131], v5 offset:45056
    v_mfma_f32_16x16x32_bf16 v[172:175], v[136:139], v[68:71], v[172:175]
    ds_read_b128 v[132:135], v5 offset:46080
    v_mfma_f32_16x16x32_bf16 v[176:179], v[140:143], v[68:71], v[176:179]
    s_waitcnt lgkmcnt(4)
    ds_read_b128 v[136:139], v5 offset:47104
    v_mfma_f32_16x16x32_bf16 v[180:183], v[144:147], v[68:71], v[180:183]
    ds_read_b128 v[140:143], v5 offset:48128
    v_mfma_f32_16x16x32_bf16 v[184:187], v[148:151], v[68:71], v[184:187]
    s_waitcnt lgkmcnt(4)
    ds_read_b128 v[144:147], v5 offset:49152
    v_mfma_f32_16x16x32_bf16 v[160:163], v[152:155], v[72:75], v[160:163]
    ds_read_b128 v[148:151], v5 offset:50176
    v_mfma_f32_16x16x32_bf16 v[164:167], v[156:159], v[72:75], v[164:167]
    s_waitcnt lgkmcnt(4)
    ds_read_b128 v[152:155], v5 offset:51200
    v_mfma_f32_16x16x32_bf16 v[168:171], v[128:131], v[72:75], v[168:171]
    ds_read_b128 v[156:159], v5 offset:52224
    v_mfma_f32_16x16x32_bf16 v[172:175], v[132:135], v[72:75], v[172:175]
    s_waitcnt lgkmcnt(4)
    ds_read_b128 v[128:131], v5 offset:53248
    v_mfma_f32_16x16x32_bf16 v[176:179], v[136:139], v[72:75], v[176:179]
    ds_read_b128 v[132:135], v5 offset:54272
    v_mfma_f32_16x16x32_bf16 v[180:183], v[140:143], v[72:75], v[180:183]
    s_waitcnt lgkmcnt(4)
    ds_read_b128 v[136:139], v5 offset:55296
    v_mfma_f32_16x16x32_bf16 v[184:187], v[144:147], v[72:75], v[184:187]
    s_waitcnt vmcnt(3)
    s_barrier
    ds_read_b128 v[140:143], v5 offset:56320
    v_mfma_f32_16x16x32_bf16 v[160:163], v[148:151], v[76:79], v[160:163]
    s_waitcnt lgkmcnt(4)
    ds_read_b128 v[144:147], v1 offset:0
    v_mfma_f32_16x16x32_bf16 v[164:167], v[152:155], v[76:79], v[164:167]
    ds_read_b128 v[148:151], v1 offset:1024
    v_mfma_f32_16x16x32_bf16 v[168:171], v[156:159], v[76:79], v[168:171]
    s_waitcnt lgkmcnt(4)
    ds_read_b128 v[152:155], v1 offset:2048
    v_mfma_f32_16x16x32_bf16 v[172:175], v[128:131], v[76:79], v[172:175]
    ds_read_b128 v[156:159], v1 offset:3072
    v_mfma_f32_16x16x32_bf16 v[176:179], v[132:135], v[76:79], v[176:179]
    s_waitcnt lgkmcnt(4)
    ds_read_b128 v[128:131], v1 offset:4096
    v_mfma_f32_16x16x32_bf16 v[180:183], v[136:139], v[76:79], v[180:183]
    ds_read_b128 v[132:135], v1 offset:5120
    v_mfma_f32_16x16x32_bf16 v[184:187], v[140:143], v[76:79], v[184:187]
    s_waitcnt lgkmcnt(4)
    ds_read_b128 v[136:139], v1 offset:6144
    v_mfma_f32_16x16x32_bf16 v[160:163], v[144:147], v[80:83], v[160:163]
    s_barrier
    ds_read_b128 v[140:143], v1 offset:7168
    v_mfma_f32_16x16x32_bf16 v[164:167], v[148:151], v[80:83], v[164:167]
    s_waitcnt lgkmcnt(4)
    ds_read_b128 v[144:147], v1 offset:8192
    v_mfma_f32_16x16x32_bf16 v[168:171], v[152:155], v[80:83], v[168:171]
    ds_read_b128 v[148:151], v1 offset:9216
    v_mfma_f32_16x16x32_bf16 v[172:175], v[156:159], v[80:83], v[172:175]
    s_waitcnt lgkmcnt(4)
    ds_read_b128 v[152:155], v1 offset:10240
    v_mfma_f32_16x16x32_bf16 v[176:179], v[128:131], v[80:83], v[176:179]
    ds_read_b128 v[156:159], v1 offset:11264
    v_mfma_f32_16x16x32_bf16 v[180:183], v[132:135], v[80:83], v[180:183]
    s_waitcnt lgkmcnt(4)
    ds_read_b128 v[128:131], v1 offset:12288
    v_mfma_f32_16x16x32_bf16 v[184:187], v[136:139], v[80:83], v[184:187]
    ds_read_b128 v[132:135], v1 offset:13312
    v_mfma_f32_16x16x32_bf16 v[160:163], v[140:143], v[84:87], v[160:163]
    s_waitcnt lgkmcnt(4)
    ds_read_b128 v[136:139], v1 offset:14336
    v_mfma_f32_16x16x32_bf16 v[164:167], v[144:147], v[84:87], v[164:167]
    ds_read_b128 v[140:143], v1 offset:15360
    v_mfma_f32_16x16x32_bf16 v[168:171], v[148:151], v[84:87], v[168:171]
    s_waitcnt lgkmcnt(4)
    ds_read_b128 v[144:147], v1 offset:16384
    v_mfma_f32_16x16x32_bf16 v[172:175], v[152:155], v[84:87], v[172:175]
    ds_read_b128 v[148:151], v1 offset:17408
    v_mfma_f32_16x16x32_bf16 v[176:179], v[156:159], v[84:87], v[176:179]
    s_waitcnt lgkmcnt(4)
    ds_read_b128 v[152:155], v1 offset:18432
    v_mfma_f32_16x16x32_bf16 v[180:183], v[128:131], v[84:87], v[180:183]
    ds_read_b128 v[156:159], v1 offset:19456
    v_mfma_f32_16x16x32_bf16 v[184:187], v[132:135], v[84:87], v[184:187]
    s_waitcnt lgkmcnt(4)
    ds_read_b128 v[128:131], v1 offset:20480
    v_mfma_f32_16x16x32_bf16 v[160:163], v[136:139], v[88:91], v[160:163]
    s_waitcnt vmcnt(0)
    s_mov_b64 exec, 1
    buffer_store_short v251, off, s[4:7], s93 sc1
    s_mov_b64 exec, -1
    ds_read_b128 v[132:135], v1 offset:21504
    v_mfma_f32_16x16x32_bf16 v[164:167], v[140:143], v[88:91], v[164:167]
    s_waitcnt lgkmcnt(4)
    ds_read_b128 v[136:139], v1 offset:22528
    s_add_u32 s85, s95, 0x0
    v_mfma_f32_16x16x32_bf16 v[168:171], v[144:147], v[88:91], v[168:171]
    s_add_u32 m0, s69, 0xe000
    ds_read_b128 v[140:143], v1 offset:23552
    buffer_load_dwordx4 v1, s[4:7], s85 offen offset:0 sc1 lds
    v_mfma_f32_16x16x32_bf16 v[172:175], v[148:151], v[88:91], v[172:175]
    s_waitcnt lgkmcnt(4)
    ds_read_b128 v[144:147], v1 offset:24576
    v_mfma_f32_16x16x32_bf16 v[176:179], v[152:155], v[88:91], v[176:179]
    ds_read_b128 v[148:151], v1 offset:25600
    v_mfma_f32_16x16x32_bf16 v[180:183], v[156:159], v[88:91], v[180:183]
    s_waitcnt lgkmcnt(4)
    ds_read_b128 v[152:155], v1 offset:26624
    buffer_load_dwordx4 v1, s[4:7], s85 offen offset:1024 sc1 lds
    v_mfma_f32_16x16x32_bf16 v[184:187], v[128:131], v[88:91], v[184:187]
    ds_read_b128 v[156:159], v1 offset:27648
    v_mfma_f32_16x16x32_bf16 v[160:163], v[132:135], v[92:95], v[160:163]
    s_waitcnt lgkmcnt(4)
    ds_read_b128 v[128:131], v1 offset:28672
    v_mfma_f32_16x16x32_bf16 v[164:167], v[136:139], v[92:95], v[164:167]
    ds_read_b128 v[132:135], v1 offset:29696
    v_mfma_f32_16x16x32_bf16 v[168:171], v[140:143], v[92:95], v[168:171]
    s_waitcnt lgkmcnt(4)
    ds_read_b128 v[136:139], v1 offset:30720
    buffer_load_dwordx4 v1, s[4:7], s85 offen offset:2048 sc1 lds
    v_mfma_f32_16x16x32_bf16 v[172:175], v[144:147], v[92:95], v[172:175]
    ds_read_b128 v[140:143], v1 offset:31744
    v_mfma_f32_16x16x32_bf16 v[176:179], v[148:151], v[92:95], v[176:179]
    s_waitcnt lgkmcnt(4)
    ds_read_b128 v[144:147], v1 offset:32768
    v_mfma_f32_16x16x32_bf16 v[180:183], v[152:155], v[92:95], v[180:183]
    ds_read_b128 v[148:151], v1 offset:33792
    v_mfma_f32_16x16x32_bf16 v[184:187], v[156:159], v[92:95], v[184:187]
    s_waitcnt lgkmcnt(4)
    ds_read_b128 v[152:155], v1 offset:34816
    buffer_load_dwordx4 v1, s[4:7], s85 offen offset:3072 sc1 lds
    v_mfma_f32_16x16x32_bf16 v[160:163], v[128:131], v[96:99], v[160:163]
    s_barrier
    ds_read_b128 v[156:159], v1 offset:35840
    v_mfma_f32_16x16x32_bf16 v[164:167], v[132:135], v[96:99], v[164:167]
    s_waitcnt lgkmcnt(4)
    ds_read_b128 v[128:131], v1 offset:36864
    v_mfma_f32_16x16x32_bf16 v[168:171], v[136:139], v[96:99], v[168:171]
    ds_read_b128 v[132:135], v1 offset:37888
    v_mfma_f32_16x16x32_bf16 v[172:175], v[140:143], v[96:99], v[172:175]
    s_waitcnt lgkmcnt(4)
    ds_read_b128 v[136:139], v1 offset:38912
    s_add_u32 s85, s95, 0x1000
    v_mfma_f32_16x16x32_bf16 v[176:179], v[144:147], v[96:99], v[176:179]
    s_add_u32 m0, s69, 0xf000
    ds_read_b128 v[140:143], v1 offset:39936
    buffer_load_dwordx4 v1, s[4:7], s85 offen offset:0 sc1 lds
    v_mfma_f32_16x16x32_bf16 v[180:183], v[148:151], v[96:99], v[180:183]
    s_waitcnt lgkmcnt(4)
    ds_read_b128 v[144:147], v1 offset:40960
    v_mfma_f32_16x16x32_bf16 v[184:187], v[152:155], v[96:99], v[184:187]
    ds_read_b128 v[148:151], v1 offset:41984
    v_mfma_f32_16x16x32_bf16 v[160:163], v[156:159], v[100:103], v[160:163]
    s_waitcnt lgkmcnt(4)
    ds_read_b128 v[152:155], v1 offset:43008
    buffer_load_dwordx4 v1, s[4:7], s85 offen offset:1024 sc1 lds
    v_mfma_f32_16x16x32_bf16 v[164:167], v[128:131], v[100:103], v[164:167]
    ds_read_b128 v[156:159], v1 offset:44032
    v_mfma_f32_16x16x32_bf16 v[168:171], v[132:135], v[100:103], v[168:171]
    s_waitcnt lgkmcnt(4)
    ds_read_b128 v[128:131], v1 offset:45056
    v_mfma_f32_16x16x32_bf16 v[172:175], v[136:139], v[100:103], v[172:175]
    ds_read_b128 v[132:135], v1 offset:46080
    v_mfma_f32_16x16x32_bf16 v[176:179], v[140:143], v[100:103], v[176:179]
    s_waitcnt lgkmcnt(4)
    ds_read_b128 v[136:139], v1 offset:47104
    buffer_load_dwordx4 v1, s[4:7], s85 offen offset:2048 sc1 lds
    v_mfma_f32_16x16x32_bf16 v[180:183], v[144:147], v[100:103], v[180:183]
    ds_read_b128 v[140:143], v1 offset:48128
    v_mfma_f32_16x16x32_bf16 v[184:187], v[148:151], v[100:103], v[184:187]
    s_waitcnt lgkmcnt(4)
    ds_read_b128 v[144:147], v1 offset:49152
    v_mfma_f32_16x16x32_bf16 v[160:163], v[152:155], v[104:107], v[160:163]
    ds_read_b128 v[148:151], v1 offset:50176
    v_mfma_f32_16x16x32_bf16 v[164:167], v[156:159], v[104:107], v[164:167]
    s_waitcnt lgkmcnt(4)
    ds_read_b128 v[152:155], v1 offset:51200
    s_add_u32 s85, s95, 0x7000
    v_mfma_f32_16x16x32_bf16 v[168:171], v[128:131], v[104:107], v[168:171]
    s_add_u32 m0, s69, 0x15000
    ds_read_b128 v[156:159], v1 offset:52224
    buffer_load_dwordx4 v1, s[4:7], s85 offen offset:0 sc1 lds
    v_mfma_f32_16x16x32_bf16 v[172:175], v[132:135], v[104:107], v[172:175]
    s_waitcnt lgkmcnt(4)
    ds_read_b128 v[128:131], v1 offset:53248
    v_mfma_f32_16x16x32_bf16 v[176:179], v[136:139], v[104:107], v[176:179]
    ds_read_b128 v[132:135], v1 offset:54272
    v_mfma_f32_16x16x32_bf16 v[180:183], v[140:143], v[104:107], v[180:183]
    s_waitcnt lgkmcnt(4)
    ds_read_b128 v[136:139], v1 offset:55296
    buffer_load_dwordx4 v1, s[4:7], s85 offen offset:1024 sc1 lds
    v_mfma_f32_16x16x32_bf16 v[184:187], v[144:147], v[104:107], v[184:187]
    ds_read_b128 v[140:143], v1 offset:56320
    v_mfma_f32_16x16x32_bf16 v[160:163], v[148:151], v[108:111], v[160:163]
    s_waitcnt lgkmcnt(4)
    ds_read_b128 v[144:147], v6 offset:0
    v_mfma_f32_16x16x32_bf16 v[164:167], v[152:155], v[108:111], v[164:167]
    ds_read_b128 v[148:151], v6 offset:1024
    v_mfma_f32_16x16x32_bf16 v[168:171], v[156:159], v[108:111], v[168:171]
    s_waitcnt lgkmcnt(4)
    ds_read_b128 v[152:155], v6 offset:2048
    buffer_load_dwordx4 v1, s[4:7], s85 offen offset:2048 sc1 lds
    v_mfma_f32_16x16x32_bf16 v[172:175], v[128:131], v[108:111], v[172:175]
    ds_read_b128 v[156:159], v6 offset:3072
    v_mfma_f32_16x16x32_bf16 v[176:179], v[132:135], v[108:111], v[176:179]
    s_waitcnt lgkmcnt(4)
    ds_read_b128 v[128:131], v6 offset:4096
    v_mfma_f32_16x16x32_bf16 v[180:183], v[136:139], v[108:111], v[180:183]
    ds_read_b128 v[132:135], v6 offset:5120
    v_mfma_f32_16x16x32_bf16 v[184:187], v[140:143], v[108:111], v[184:187]
    s_waitcnt lgkmcnt(4)
    ds_read_b128 v[136:139], v6 offset:6144
    buffer_load_dwordx4 v1, s[4:7], s85 offen offset:3072 sc1 lds
    v_mfma_f32_16x16x32_bf16 v[160:163], v[144:147], v[112:115], v[160:163]
    s_barrier
    ds_read_b128 v[140:143], v6 offset:7168
    v_mfma_f32_16x16x32_bf16 v[164:167], v[148:151], v[112:115], v[164:167]
    s_waitcnt lgkmcnt(4)
    ds_read_b128 v[144:147], v6 offset:8192
    v_mfma_f32_16x16x32_bf16 v[168:171], v[152:155], v[112:115], v[168:171]
    ds_read_b128 v[148:151], v6 offset:9216
    v_mfma_f32_16x16x32_bf16 v[172:175], v[156:159], v[112:115], v[172:175]
    s_waitcnt lgkmcnt(4)
    ds_read_b128 v[152:155], v6 offset:10240
    s_add_u32 s85, s95, 0x8000
    v_mfma_f32_16x16x32_bf16 v[176:179], v[128:131], v[112:115], v[176:179]
    s_add_u32 m0, s69, 0x16000
    ds_read_b128 v[156:159], v6 offset:11264
    buffer_load_dwordx4 v1, s[4:7], s85 offen offset:0 sc1 lds
    v_mfma_f32_16x16x32_bf16 v[180:183], v[132:135], v[112:115], v[180:183]
    s_waitcnt lgkmcnt(4)
    ds_read_b128 v[128:131], v6 offset:12288
    v_mfma_f32_16x16x32_bf16 v[184:187], v[136:139], v[112:115], v[184:187]
    ds_read_b128 v[132:135], v6 offset:13312
    v_mfma_f32_16x16x32_bf16 v[160:163], v[140:143], v[116:119], v[160:163]
    s_waitcnt lgkmcnt(4)
    ds_read_b128 v[136:139], v6 offset:14336
    buffer_load_dwordx4 v1, s[4:7], s85 offen offset:1024 sc1 lds
    v_mfma_f32_16x16x32_bf16 v[164:167], v[144:147], v[116:119], v[164:167]
    ds_read_b128 v[140:143], v6 offset:15360
    v_mfma_f32_16x16x32_bf16 v[168:171], v[148:151], v[116:119], v[168:171]
    s_waitcnt lgkmcnt(4)
    ds_read_b128 v[144:147], v6 offset:16384
    v_mfma_f32_16x16x32_bf16 v[172:175], v[152:155], v[116:119], v[172:175]
    ds_read_b128 v[148:151], v6 offset:17408
    v_mfma_f32_16x16x32_bf16 v[176:179], v[156:159], v[116:119], v[176:179]
    s_waitcnt lgkmcnt(4)
    ds_read_b128 v[152:155], v6 offset:18432
    buffer_load_dwordx4 v1, s[4:7], s85 offen offset:2048 sc1 lds
    v_mfma_f32_16x16x32_bf16 v[180:183], v[128:131], v[116:119], v[180:183]
    ds_read_b128 v[156:159], v6 offset:19456
    v_mfma_f32_16x16x32_bf16 v[184:187], v[132:135], v[116:119], v[184:187]
    s_waitcnt lgkmcnt(4)
    ds_read_b128 v[128:131], v6 offset:20480
    v_mfma_f32_16x16x32_bf16 v[160:163], v[136:139], v[120:123], v[160:163]
    ds_read_b128 v[132:135], v6 offset:21504
    v_mfma_f32_16x16x32_bf16 v[164:167], v[140:143], v[120:123], v[164:167]
    s_waitcnt lgkmcnt(4)
    ds_read_b128 v[136:139], v6 offset:22528
    s_add_u32 s85, s95, 0xe000
    v_mfma_f32_16x16x32_bf16 v[168:171], v[144:147], v[120:123], v[168:171]
    s_add_u32 m0, s69, 0x0
    ds_read_b128 v[140:143], v6 offset:23552
    buffer_load_dwordx4 v1, s[4:7], s85 offen offset:0 sc1 lds
    v_mfma_f32_16x16x32_bf16 v[172:175], v[148:151], v[120:123], v[172:175]
    s_waitcnt lgkmcnt(4)
    ds_read_b128 v[144:147], v6 offset:24576
    v_mfma_f32_16x16x32_bf16 v[176:179], v[152:155], v[120:123], v[176:179]
    ds_read_b128 v[148:151], v6 offset:25600
    v_mfma_f32_16x16x32_bf16 v[180:183], v[156:159], v[120:123], v[180:183]
    s_waitcnt lgkmcnt(4)
    ds_read_b128 v[152:155], v6 offset:26624
    buffer_load_dwordx4 v1, s[4:7], s85 offen offset:1024 sc1 lds
    v_mfma_f32_16x16x32_bf16 v[184:187], v[128:131], v[120:123], v[184:187]
    ds_read_b128 v[156:159], v6 offset:27648
    v_mfma_f32_16x16x32_bf16 v[160:163], v[132:135], v[124:127], v[160:163]
    s_waitcnt lgkmcnt(4)
    v_mfma_f32_16x16x32_bf16 v[164:167], v[136:139], v[124:127], v[164:167]
    v_mfma_f32_16x16x32_bf16 v[168:171], v[140:143], v[124:127], v[168:171]
    s_waitcnt lgkmcnt(2)
    buffer_load_dwordx4 v1, s[4:7], s85 offen offset:2048 sc1 lds
    v_mfma_f32_16x16x32_bf16 v[172:175], v[144:147], v[124:127], v[172:175]
    v_mfma_f32_16x16x32_bf16 v[176:179], v[148:151], v[124:127], v[176:179]
    s_waitcnt lgkmcnt(0)
    v_mfma_f32_16x16x32_bf16 v[180:183], v[152:155], v[124:127], v[180:183]
    v_mfma_f32_16x16x32_bf16 v[184:187], v[156:159], v[124:127], v[184:187]
    buffer_load_dwordx4 v1, s[4:7], s85 offen offset:3072 sc1 lds
    s_barrier
    v_pk_fma_f32 v[160:161], v[160:161], v[52:53], v[188:189] op_sel_hi:[1,0,1]
    v_pk_mul_f32 v[216:217], v[160:161], v[160:161]
    v_pk_fma_f32 v[216:217], v[216:217], v[56:57], v[56:57] op_sel:[0,0,1] op_sel_hi:[1,0,1]
    v_pk_mul_f32 v[216:217], v[216:217], v[160:161]
    v_exp_f32 v216, v216
    v_exp_f32 v217, v217
    s_add_u32 s85, s95, 0xf000
    s_add_u32 m0, s69, 0x1000
    s_nop 0
    buffer_load_dwordx4 v1, s[4:7], s85 offen offset:0 sc1 lds
    v_pk_fma_f32 v[162:163], v[162:163], v[52:53], v[190:191] op_sel_hi:[1,0,1]
    v_pk_mul_f32 v[218:219], v[162:163], v[162:163]
    v_pk_fma_f32 v[218:219], v[218:219], v[56:57], v[56:57] op_sel:[0,0,1] op_sel_hi:[1,0,1]
    v_pk_mul_f32 v[218:219], v[218:219], v[162:163]
    v_exp_f32 v218, v218
    v_exp_f32 v219, v219
    v_pk_add_f32 v[216:217], v[216:217], 1.0 op_sel_hi:[1,0]
    v_rcp_f32 v216, v216
    v_rcp_f32 v217, v217
    buffer_load_dwordx4 v1, s[4:7], s85 offen offset:1024 sc1 lds
    v_pk_fma_f32 v[164:165], v[164:165], v[52:53], v[192:193] op_sel_hi:[1,0,1]
    v_pk_mul_f32 v[220:221], v[164:165], v[164:165]
    v_pk_fma_f32 v[220:221], v[220:221], v[56:57], v[56:57] op_sel:[0,0,1] op_sel_hi:[1,0,1]
    v_pk_mul_f32 v[220:221], v[220:221], v[164:165]
    v_exp_f32 v220, v220
    v_exp_f32 v221, v221
    v_pk_add_f32 v[218:219], v[218:219], 1.0 op_sel_hi:[1,0]
    v_rcp_f32 v218, v218
    v_rcp_f32 v219, v219
    v_pk_mul_f32 v[160:161], v[160:161], v[216:217]
    buffer_load_dwordx4 v1, s[4:7], s85 offen offset:2048 sc1 lds
    v_pk_fma_f32 v[166:167], v[166:167], v[52:53], v[194:195] op_sel_hi:[1,0,1]
    v_pk_mul_f32 v[216:217], v[166:167], v[166:167]
    v_pk_fma_f32 v[216:217], v[216:217], v[56:57], v[56:57] op_sel:[0,0,1] op_sel_hi:[1,0,1]
    v_pk_mul_f32 v[216:217], v[216:217], v[166:167]
    v_exp_f32 v216, v216
    v_exp_f32 v217, v217
    v_pk_add_f32 v[220:221], v[220:221], 1.0 op_sel_hi:[1,0]
    v_rcp_f32 v220, v220
    v_rcp_f32 v221, v221
    v_pk_mul_f32 v[162:163], v[162:163], v[218:219]
    s_add_u32 s85, s95, 0x15000
    s_add_u32 m0, s69, 0x7000
    s_nop 0
    buffer_load_dwordx4 v1, s[4:7], s85 offen offset:0 sc1 lds
    buffer_load_ubyte v250, v0, s[4:7], s94 offen offset:0 sc1
    v_pk_fma_f32 v[168:169], v[168:169], v[52:53], v[196:197] op_sel_hi:[1,0,1]
    v_pk_mul_f32 v[218:219], v[168:169], v[168:169]
    v_pk_fma_f32 v[218:219], v[218:219], v[56:57], v[56:57] op_sel:[0,0,1] op_sel_hi:[1,0,1]
    v_pk_mul_f32 v[218:219], v[218:219], v[168:169]
    v_exp_f32 v218, v218
    v_exp_f32 v219, v219
    v_pk_add_f32 v[216:217], v[216:217], 1.0 op_sel_hi:[1,0]
    v_rcp_f32 v216, v216
    v_rcp_f32 v217, v217
    v_pk_mul_f32 v[164:165], v[164:165], v[220:221]
    buffer_load_dwordx4 v1, s[4:7], s85 offen offset:1024 sc1 lds
    v_pk_fma_f32 v[170:171], v[170:171], v[52:53], v[198:199] op_sel_hi:[1,0,1]
    v_pk_mul_f32 v[220:221], v[170:171], v[170:171]
    v_pk_fma_f32 v[220:221], v[220:221], v[56:57], v[56:57] op_sel:[0,0,1] op_sel_hi:[1,0,1]
    v_pk_mul_f32 v[220:221], v[220:221], v[170:171]
    v_exp_f32 v220, v220
    v_exp_f32 v221, v221
    v_pk_add_f32 v[218:219], v[218:219], 1.0 op_sel_hi:[1,0]
    v_rcp_f32 v218, v218
    v_rcp_f32 v219, v219
    v_pk_mul_f32 v[166:167], v[166:167], v[216:217]
    buffer_load_dwordx4 v1, s[4:7], s85 offen offset:2048 sc1 lds
    v_pk_fma_f32 v[172:173], v[172:173], v[52:53], v[200:201] op_sel_hi:[1,0,1]
    v_pk_mul_f32 v[216:217], v[172:173], v[172:173]
    v_pk_fma_f32 v[216:217], v[216:217], v[56:57], v[56:57] op_sel:[0,0,1] op_sel_hi:[1,0,1]
    v_pk_mul_f32 v[216:217], v[216:217], v[172:173]
    v_exp_f32 v216, v216
    v_exp_f32 v217, v217
    v_pk_add_f32 v[220:221], v[220:221], 1.0 op_sel_hi:[1,0]
    v_rcp_f32 v220, v220
    v_rcp_f32 v221, v221
    v_pk_mul_f32 v[168:169], v[168:169], v[218:219]
    buffer_load_dwordx4 v1, s[4:7], s85 offen offset:3072 sc1 lds
    v_pk_fma_f32 v[174:175], v[174:175], v[52:53], v[202:203] op_sel_hi:[1,0,1]
    v_pk_mul_f32 v[218:219], v[174:175], v[174:175]
    v_pk_fma_f32 v[218:219], v[218:219], v[56:57], v[56:57] op_sel:[0,0,1] op_sel_hi:[1,0,1]
    v_pk_mul_f32 v[218:219], v[218:219], v[174:175]
    v_exp_f32 v218, v218
    v_exp_f32 v219, v219
    v_pk_add_f32 v[216:217], v[216:217], 1.0 op_sel_hi:[1,0]
    v_rcp_f32 v216, v216
    v_rcp_f32 v217, v217
    v_pk_mul_f32 v[170:171], v[170:171], v[220:221]
    s_add_u32 s85, s95, 0x16000
    s_add_u32 m0, s69, 0x8000
    s_nop 0
    buffer_load_dwordx4 v1, s[4:7], s85 offen offset:0 sc1 lds
    v_pk_fma_f32 v[176:177], v[176:177], v[52:53], v[204:205] op_sel_hi:[1,0,1]
    v_pk_mul_f32 v[220:221], v[176:177], v[176:177]
    v_pk_fma_f32 v[220:221], v[220:221], v[56:57], v[56:57] op_sel:[0,0,1] op_sel_hi:[1,0,1]
    v_pk_mul_f32 v[220:221], v[220:221], v[176:177]
    v_exp_f32 v220, v220
    v_exp_f32 v221, v221
    v_pk_add_f32 v[218:219], v[218:219], 1.0 op_sel_hi:[1,0]
    v_rcp_f32 v218, v218
    v_rcp_f32 v219, v219
    v_pk_mul_f32 v[172:173], v[172:173], v[216:217]
    buffer_load_dwordx4 v1, s[4:7], s85 offen offset:1024 sc1 lds
    v_pk_fma_f32 v[178:179], v[178:179], v[52:53], v[206:207] op_sel_hi:[1,0,1]
    v_pk_mul_f32 v[216:217], v[178:179], v[178:179]
    v_pk_fma_f32 v[216:217], v[216:217], v[56:57], v[56:57] op_sel:[0,0,1] op_sel_hi:[1,0,1]
    v_pk_mul_f32 v[216:217], v[216:217], v[178:179]
    v_exp_f32 v216, v216
    v_exp_f32 v217, v217
    v_pk_add_f32 v[220:221], v[220:221], 1.0 op_sel_hi:[1,0]
    v_rcp_f32 v220, v220
    v_rcp_f32 v221, v221
    v_pk_mul_f32 v[174:175], v[174:175], v[218:219]
    buffer_load_dwordx4 v1, s[4:7], s85 offen offset:2048 sc1 lds
    v_pk_fma_f32 v[180:181], v[180:181], v[52:53], v[208:209] op_sel_hi:[1,0,1]
    v_pk_mul_f32 v[218:219], v[180:181], v[180:181]
    v_pk_fma_f32 v[218:219], v[218:219], v[56:57], v[56:57] op_sel:[0,0,1] op_sel_hi:[1,0,1]
    v_pk_mul_f32 v[218:219], v[218:219], v[180:181]
    v_exp_f32 v218, v218
    v_exp_f32 v219, v219
    v_pk_add_f32 v[216:217], v[216:217], 1.0 op_sel_hi:[1,0]
    v_rcp_f32 v216, v216
    v_rcp_f32 v217, v217
    v_pk_mul_f32 v[176:177], v[176:177], v[220:221]
    v_pk_fma_f32 v[182:183], v[182:183], v[52:53], v[210:211] op_sel_hi:[1,0,1]
    v_pk_mul_f32 v[220:221], v[182:183], v[182:183]
    v_pk_fma_f32 v[220:221], v[220:221], v[56:57], v[56:57] op_sel:[0,0,1] op_sel_hi:[1,0,1]
    v_pk_mul_f32 v[220:221], v[220:221], v[182:183]
    v_exp_f32 v220, v220
    v_exp_f32 v221, v221
    v_pk_add_f32 v[218:219], v[218:219], 1.0 op_sel_hi:[1,0]
    v_rcp_f32 v218, v218
    v_rcp_f32 v219, v219
    v_pk_mul_f32 v[178:179], v[178:179], v[216:217]
    s_waitcnt vmcnt(6)
    v_cmp_gt_u32 vcc, s55, v250
    s_cbranch_vccnz L_rt_24
L_bk_25:
    s_cmp_lg_u32 s66, 0
    s_cbranch_scc1 L_skip_26
    s_add_u32 s85, s73, 2048
    s_add_u32 m0, s60, 142080
    s_nop 0
    buffer_load_dwordx4 v252, s[8:11], s85 offen lds
    s_add_u32 s85, s73, 4096
    s_add_u32 m0, s60, 143136
    s_nop 0
    buffer_load_dwordx4 v252, s[8:11], s85 offen lds
    s_add_u32 s85, s73, 6144
    s_add_u32 m0, s60, 144192
    s_nop 0
    buffer_load_dwordx4 v252, s[8:11], s85 offen lds
    s_add_u32 s85, s73, 8192
    s_add_u32 m0, s60, 145248
    s_nop 0
    buffer_load_dwordx4 v252, s[8:11], s85 offen lds
    global_load_dword v254, v240, s[0:1]
L_skip_26:
    s_add_u32 s80, s36, 0
    buffer_load_dwordx4 v[64:67], v1, s[4:7], s80 offen offset:0 sc1
    buffer_load_dwordx4 v[68:71], v1, s[4:7], s80 offen offset:1024 sc1
    buffer_load_dwordx4 v[72:75], v1, s[4:7], s80 offen offset:2048 sc1
    v_pk_fma_f32 v[184:185], v[184:185], v[52:53], v[212:213] op_sel_hi:[1,0,1]
    v_pk_mul_f32 v[216:217], v[184:185], v[184:185]
    v_pk_fma_f32 v[216:217], v[216:217], v[56:57], v[56:57] op_sel:[0,0,1] op_sel_hi:[1,0,1]
    v_pk_mul_f32 v[216:217], v[216:217], v[184:185]
    v_exp_f32 v216, v216
    v_exp_f32 v217, v217
    v_pk_add_f32 v[220:221], v[220:221], 1.0 op_sel_hi:[1,0]
    v_rcp_f32 v220, v220
    v_rcp_f32 v221, v221
    v_pk_mul_f32 v[180:181], v[180:181], v[218:219]
    buffer_load_dwordx4 v[76:79], v1, s[4:7], s80 offen offset:3072 sc1
    v_pk_fma_f32 v[186:187], v[186:187], v[52:53], v[214:215] op_sel_hi:[1,0,1]
    v_pk_mul_f32 v[218:219], v[186:187], v[186:187]
    v_pk_fma_f32 v[218:219], v[218:219], v[56:57], v[56:57] op_sel:[0,0,1] op_sel_hi:[1,0,1]
    v_pk_mul_f32 v[218:219], v[218:219], v[186:187]
    v_exp_f32 v218, v218
    v_exp_f32 v219, v219
    v_pk_add_f32 v[216:217], v[216:217], 1.0 op_sel_hi:[1,0]
    v_rcp_f32 v216, v216
    v_rcp_f32 v217, v217
    v_pk_mul_f32 v[182:183], v[182:183], v[220:221]
    s_add_u32 s80, s36, 4096
    buffer_load_dwordx4 v[80:83], v1, s[4:7], s80 offen offset:0 sc1
    v_pk_add_f32 v[218:219], v[218:219], 1.0 op_sel_hi:[1,0]
    v_rcp_f32 v218, v218
    v_rcp_f32 v219, v219
    v_pk_mul_f32 v[184:185], v[184:185], v[216:217]
    buffer_load_dwordx4 v[84:87], v1, s[4:7], s80 offen offset:1024 sc1
    v_pk_mul_f32 v[186:187], v[186:187], v[218:219]
    buffer_load_dwordx4 v[88:91], v1, s[4:7], s80 offen offset:2048 sc1
    buffer_load_dwordx4 v[92:95], v1, s[4:7], s80 offen offset:3072 sc1
    s_add_u32 s80, s36, 8192
    buffer_load_dwordx4 v[96:99], v1, s[4:7], s80 offen offset:0 sc1
    buffer_load_dwordx4 v[100:103], v1, s[4:7], s80 offen offset:1024 sc1
    buffer_load_dwordx4 v[104:107], v1, s[4:7], s80 offen offset:2048 sc1
    buffer_load_dwordx4 v[108:111], v1, s[4:7], s80 offen offset:3072 sc1
    v_mov_b32 v56, v4
    v_mov_b32 v57, v4
    v_mov_b32 v58, v4
    v_mov_b32 v59, v4
    s_waitcnt vmcnt(11)
    s_nop 0
    v_mfma_f32_16x16x32_bf16 v[16:19], v[64:67], a[0:3], v[56:59]
    s_add_u32 s80, s36, 12288
    buffer_load_dwordx4 v[112:115], v1, s[4:7], s80 offen offset:0 sc1
    v_mfma_f32_16x16x32_bf16 v[196:199], v[64:67], a[4:7], 0
    v_mfma_f32_16x16x32_bf16 v[200:203], v[64:67], a[8:11], 0
    v_mfma_f32_16x16x32_bf16 v[204:207], v[64:67], a[12:15], 0
    s_waitcnt vmcnt(11)
    v_mfma_f32_16x16x32_bf16 v[16:19], v[68:71], a[16:19], v[16:19]
    buffer_load_dwordx4 v[116:119], v1, s[4:7], s80 offen offset:1024 sc1
    v_mfma_f32_16x16x32_bf16 v[196:199], v[68:71], a[20:23], v[196:199]
    v_mfma_f32_16x16x32_bf16 v[200:203], v[68:71], a[24:27], v[200:203]
    v_mfma_f32_16x16x32_bf16 v[204:207], v[68:71], a[28:31], v[204:207]
    s_waitcnt vmcnt(11)
    v_mfma_f32_16x16x32_bf16 v[16:19], v[72:75], a[32:35], v[16:19]
    buffer_load_dwordx4 v[120:123], v1, s[4:7], s80 offen offset:2048 sc1
    v_mfma_f32_16x16x32_bf16 v[196:199], v[72:75], a[36:39], v[196:199]
    v_mfma_f32_16x16x32_bf16 v[200:203], v[72:75], a[40:43], v[200:203]
    v_mfma_f32_16x16x32_bf16 v[204:207], v[72:75], a[44:47], v[204:207]
    s_waitcnt vmcnt(11)
    v_mfma_f32_16x16x32_bf16 v[16:19], v[76:79], a[48:51], v[16:19]
    buffer_load_dwordx4 v[124:127], v1, s[4:7], s80 offen offset:3072 sc1
    v_mfma_f32_16x16x32_bf16 v[196:199], v[76:79], a[52:55], v[196:199]
    v_mfma_f32_16x16x32_bf16 v[200:203], v[76:79], a[56:59], v[200:203]
    v_mfma_f32_16x16x32_bf16 v[204:207], v[76:79], a[60:63], v[204:207]
    s_waitcnt vmcnt(11)
    v_mfma_f32_16x16x32_bf16 v[16:19], v[80:83], a[64:67], v[16:19]
    s_add_u32 s80, s36, 16384
    buffer_load_dwordx4 v[128:131], v1, s[4:7], s80 offen offset:0 sc1
    v_mfma_f32_16x16x32_bf16 v[196:199], v[80:83], a[68:71], v[196:199]
    v_mfma_f32_16x16x32_bf16 v[200:203], v[80:83], a[72:75], v[200:203]
    v_mfma_f32_16x16x32_bf16 v[204:207], v[80:83], a[76:79], v[204:207]
    s_waitcnt vmcnt(11)
    v_mfma_f32_16x16x32_bf16 v[16:19], v[84:87], a[80:83], v[16:19]
    buffer_load_dwordx4 v[132:135], v1, s[4:7], s80 offen offset:1024 sc1
    v_mfma_f32_16x16x32_bf16 v[196:199], v[84:87], a[84:87], v[196:199]
    v_mfma_f32_16x16x32_bf16 v[200:203], v[84:87], a[88:91], v[200:203]
    v_mfma_f32_16x16x32_bf16 v[204:207], v[84:87], a[92:95], v[204:207]
    s_waitcnt vmcnt(11)
    v_mfma_f32_16x16x32_bf16 v[16:19], v[88:91], a[96:99], v[16:19]
    buffer_load_dwordx4 v[136:139], v1, s[4:7], s80 offen offset:2048 sc1
    v_mfma_f32_16x16x32_bf16 v[196:199], v[88:91], a[100:103], v[196:199]
    v_mfma_f32_16x16x32_bf16 v[200:203], v[88:91], a[104:107], v[200:203]
    v_mfma_f32_16x16x32_bf16 v[204:207], v[88:91], a[108:111], v[204:207]
    s_waitcnt vmcnt(11)
    v_mfma_f32_16x16x32_bf16 v[16:19], v[92:95], a[112:115], v[16:19]
    buffer_load_dwordx4 v[140:143], v1, s[4:7], s80 offen offset:3072 sc1
    v_mfma_f32_16x16x32_bf16 v[196:199], v[92:95], a[116:119], v[196:199]
    v_mfma_f32_16x16x32_bf16 v[200:203], v[92:95], a[120:123], v[200:203]
    v_mfma_f32_16x16x32_bf16 v[204:207], v[92:95], a[124:127], v[204:207]
    s_waitcnt vmcnt(11)
    v_mfma_f32_16x16x32_bf16 v[16:19], v[96:99], a[128:131], v[16:19]
    s_add_u32 s80, s36, 20480
    buffer_load_dwordx4 v[144:147], v1, s[4:7], s80 offen offset:0 sc1
    v_mfma_f32_16x16x32_bf16 v[196:199], v[96:99], a[132:135], v[196:199]
    v_mfma_f32_16x16x32_bf16 v[200:203], v[96:99], a[136:139], v[200:203]
    v_mfma_f32_16x16x32_bf16 v[204:207], v[96:99], a[140:143], v[204:207]
    s_waitcnt vmcnt(11)
    v_mfma_f32_16x16x32_bf16 v[16:19], v[100:103], a[144:147], v[16:19]
    buffer_load_dwordx4 v[148:151], v1, s[4:7], s80 offen offset:1024 sc1
    v_mfma_f32_16x16x32_bf16 v[196:199], v[100:103], a[148:151], v[196:199]
    v_mfma_f32_16x16x32_bf16 v[200:203], v[100:103], a[152:155], v[200:203]
    v_mfma_f32_16x16x32_bf16 v[204:207], v[100:103], a[156:159], v[204:207]
    s_waitcnt vmcnt(11)
    v_mfma_f32_16x16x32_bf16 v[16:19], v[104:107], a[160:163], v[16:19]
    buffer_load_dwordx4 v[152:155], v1, s[4:7], s80 offen offset:2048 sc1
    v_mfma_f32_16x16x32_bf16 v[196:199], v[104:107], a[164:167], v[196:199]
    v_mfma_f32_16x16x32_bf16 v[200:203], v[104:107], a[168:171], v[200:203]
    v_mfma_f32_16x16x32_bf16 v[204:207], v[104:107], a[172:175], v[204:207]
    s_waitcnt vmcnt(11)
    v_mfma_f32_16x16x32_bf16 v[16:19], v[108:111], a[176:179], v[16:19]
    buffer_load_dwordx4 v[156:159], v1, s[4:7], s80 offen offset:3072 sc1
    v_mfma_f32_16x16x32_bf16 v[196:199], v[108:111], a[180:183], v[196:199]
    v_mfma_f32_16x16x32_bf16 v[200:203], v[108:111], a[184:187], v[200:203]
    v_mfma_f32_16x16x32_bf16 v[204:207], v[108:111], a[188:191], v[204:207]
    s_waitcnt vmcnt(11)
    v_mfma_f32_16x16x32_bf16 v[16:19], v[112:115], a[192:195], v[16:19]
    s_add_u32 s80, s36, 24576
    buffer_load_dwordx4 v[64:67], v1, s[4:7], s80 offen offset:0 sc1
    v_mfma_f32_16x16x32_bf16 v[196:199], v[112:115], a[196:199], v[196:199]
    v_mfma_f32_16x16x32_bf16 v[200:203], v[112:115], a[200:203], v[200:203]
    v_mfma_f32_16x16x32_bf16 v[204:207], v[112:115], a[204:207], v[204:207]
    s_waitcnt vmcnt(11)
    v_mfma_f32_16x16x32_bf16 v[16:19], v[116:119], a[208:211], v[16:19]
    buffer_load_dwordx4 v[68:71], v1, s[4:7], s80 offen offset:1024 sc1
    v_mfma_f32_16x16x32_bf16 v[196:199], v[116:119], a[212:215], v[196:199]
    v_mfma_f32_16x16x32_bf16 v[200:203], v[116:119], a[216:219], v[200:203]
    v_mfma_f32_16x16x32_bf16 v[204:207], v[116:119], a[220:223], v[204:207]
    s_waitcnt vmcnt(11)
    v_mfma_f32_16x16x32_bf16 v[16:19], v[120:123], a[224:227], v[16:19]
    buffer_load_dwordx4 v[72:75], v1, s[4:7], s80 offen offset:2048 sc1
    v_mfma_f32_16x16x32_bf16 v[196:199], v[120:123], a[228:231], v[196:199]
    v_mfma_f32_16x16x32_bf16 v[200:203], v[120:123], a[232:235], v[200:203]
    v_mfma_f32_16x16x32_bf16 v[204:207], v[120:123], a[236:239], v[204:207]
    s_waitcnt vmcnt(11)
    v_mfma_f32_16x16x32_bf16 v[16:19], v[124:127], a[240:243], v[16:19]
    buffer_load_dwordx4 v[76:79], v1, s[4:7], s80 offen offset:3072 sc1
    v_mfma_f32_16x16x32_bf16 v[196:199], v[124:127], a[244:247], v[196:199]
    v_mfma_f32_16x16x32_bf16 v[200:203], v[124:127], a[248:251], v[200:203]
    v_mfma_f32_16x16x32_bf16 v[204:207], v[124:127], a[252:255], v[204:207]
    s_waitcnt vmcnt(11)
    v_mfma_f32_16x16x32_bf16 v[20:23], v[128:131], a[0:3], v[56:59]
    s_add_u32 s80, s36, 28672
    buffer_load_dwordx4 v[80:83], v1, s[4:7], s80 offen offset:0 sc1
    v_mfma_f32_16x16x32_bf16 v[208:211], v[128:131], a[4:7], 0
    v_mfma_f32_16x16x32_bf16 v[212:215], v[128:131], a[8:11], 0
    v_mfma_f32_16x16x32_bf16 v[216:219], v[128:131], a[12:15], 0
    s_waitcnt vmcnt(11)
    ds_write_b128 v235, v[196:199] offset:0
    v_mfma_f32_16x16x32_bf16 v[20:23], v[132:135], a[16:19], v[20:23]
    buffer_load_dwordx4 v[84:87], v1, s[4:7], s80 offen offset:1024 sc1
    v_mfma_f32_16x16x32_bf16 v[208:211], v[132:135], a[20:23], v[208:211]
    v_mfma_f32_16x16x32_bf16 v[212:215], v[132:135], a[24:27], v[212:215]
    ds_write_b128 v236, v[200:203] offset:0
    v_mfma_f32_16x16x32_bf16 v[216:219], v[132:135], a[28:31], v[216:219]
    s_waitcnt vmcnt(11)
    v_mfma_f32_16x16x32_bf16 v[20:23], v[136:139], a[32:35], v[20:23]
    buffer_load_dwordx4 v[88:91], v1, s[4:7], s80 offen offset:2048 sc1
    v_mfma_f32_16x16x32_bf16 v[208:211], v[136:139], a[36:39], v[208:211]
    ds_write_b128 v237, v[204:207] offset:0
    v_mfma_f32_16x16x32_bf16 v[212:215], v[136:139], a[40:43], v[212:215]
    v_mfma_f32_16x16x32_bf16 v[216:219], v[136:139], a[44:47], v[216:219]
    s_waitcnt vmcnt(11)
    v_mfma_f32_16x16x32_bf16 v[20:23], v[140:143], a[48:51], v[20:23]
    buffer_load_dwordx4 v[92:95], v1, s[4:7], s80 offen offset:3072 sc1
    v_mfma_f32_16x16x32_bf16 v[208:211], v[140:143], a[52:55], v[208:211]
    v_mfma_f32_16x16x32_bf16 v[212:215], v[140:143], a[56:59], v[212:215]
    v_mfma_f32_16x16x32_bf16 v[216:219], v[140:143], a[60:63], v[216:219]
    s_waitcnt vmcnt(11)
    s_waitcnt lgkmcnt(0)
    s_barrier
    v_mfma_f32_16x16x32_bf16 v[20:23], v[144:147], a[64:67], v[20:23]
    s_add_u32 s80, s36, 32768
    buffer_load_dwordx4 v[96:99], v1, s[4:7], s80 offen offset:0 sc1
    ds_read_b128 v[188:191], v238 offset:0
    v_mfma_f32_16x16x32_bf16 v[208:211], v[144:147], a[68:71], v[208:211]
    ds_read_b128 v[192:195], v238 offset:1024
    v_mfma_f32_16x16x32_bf16 v[212:215], v[144:147], a[72:75], v[212:215]
    ds_read_b128 v[52:55], v238 offset:2048
    v_mfma_f32_16x16x32_bf16 v[216:219], v[144:147], a[76:79], v[216:219]
    s_waitcnt vmcnt(11)
    v_mfma_f32_16x16x32_bf16 v[20:23], v[148:151], a[80:83], v[20:23]
    buffer_load_dwordx4 v[100:103], v1, s[4:7], s80 offen offset:1024 sc1
    v_mfma_f32_16x16x32_bf16 v[208:211], v[148:151], a[84:87], v[208:211]
    v_mfma_f32_16x16x32_bf16 v[212:215], v[148:151], a[88:91], v[212:215]
    v_mfma_f32_16x16x32_bf16 v[216:219], v[148:151], a[92:95], v[216:219]
    s_waitcnt vmcnt(11)
    s_waitcnt lgkmcnt(0)
    v_mfma_f32_16x16x32_bf16 v[20:23], v[152:155], a[96:99], v[20:23]
    buffer_load_dwordx4 v[104:107], v1, s[4:7], s80 offen offset:2048 sc1
    v_add_f32 v188, v188, v192
    v_mfma_f32_16x16x32_bf16 v[208:211], v[152:155], a[100:103], v[208:211]
    v_add_f32 v16, v16, v52
    v_mfma_f32_16x16x32_bf16 v[212:215], v[152:155], a[104:107], v[212:215]
    v_add_f32 v189, v189, v193
    v_mfma_f32_16x16x32_bf16 v[216:219], v[152:155], a[108:111], v[216:219]
    s_waitcnt vmcnt(11)
    v_add_f32 v17, v17, v53
    v_mfma_f32_16x16x32_bf16 v[20:23], v[156:159], a[112:115], v[20:23]
    buffer_load_dwordx4 v[108:111], v1, s[4:7], s80 offen offset:3072 sc1
    v_add_f32 v190, v190, v194
    v_mfma_f32_16x16x32_bf16 v[208:211], v[156:159], a[116:119], v[208:211]
    v_add_f32 v18, v18, v54
    v_mfma_f32_16x16x32_bf16 v[212:215], v[156:159], a[120:123], v[212:215]
    v_add_f32 v191, v191, v195
    v_mfma_f32_16x16x32_bf16 v[216:219], v[156:159], a[124:127], v[216:219]
    s_waitcnt vmcnt(11)
    v_add_f32 v19, v19, v55
    v_mfma_f32_16x16x32_bf16 v[20:23], v[64:67], a[128:131], v[20:23]
    s_add_u32 s80, s36, 36864
    buffer_load_dwordx4 v[112:115], v1, s[4:7], s80 offen offset:0 sc1
    v_add_f32 v188, v188, v16
    v_mfma_f32_16x16x32_bf16 v[208:211], v[64:67], a[132:135], v[208:211]
    v_add_f32 v189, v189, v17
    v_mfma_f32_16x16x32_bf16 v[212:215], v[64:67], a[136:139], v[212:215]
    v_add_f32 v190, v190, v18
    v_mfma_f32_16x16x32_bf16 v[216:219], v[64:67], a[140:143], v[216:219]
    s_waitcnt vmcnt(11)
    v_add_f32 v191, v191, v19
    v_mfma_f32_16x16x32_bf16 v[20:23], v[68:71], a[144:147], v[20:23]
    buffer_load_dwordx4 v[116:119], v1, s[4:7], s80 offen offset:1024 sc1
    v_mul_f32 v188, v188, v160
    v_mfma_f32_16x16x32_bf16 v[208:211], v[68:71], a[148:151], v[208:211]
    v_mul_f32 v189, v189, v161
    v_mfma_f32_16x16x32_bf16 v[212:215], v[68:71], a[152:155], v[212:215]
    v_mul_f32 v190, v190, v162
    v_mfma_f32_16x16x32_bf16 v[216:219], v[68:71], a[156:159], v[216:219]
    s_waitcnt vmcnt(11)
    v_mul_f32 v191, v191, v163
    v_mfma_f32_16x16x32_bf16 v[20:23], v[72:75], a[160:163], v[20:23]
    buffer_load_dwordx4 v[120:123], v1, s[4:7], s80 offen offset:2048 sc1
    v_cvt_pk_bf16_f32 v220, v188, v189
    v_mfma_f32_16x16x32_bf16 v[208:211], v[72:75], a[164:167], v[208:211]
    v_cvt_pk_bf16_f32 v221, v190, v191
    v_mfma_f32_16x16x32_bf16 v[212:215], v[72:75], a[168:171], v[212:215]
    v_mfma_f32_16x16x32_bf16 v[216:219], v[72:75], a[172:175], v[216:219]
    s_waitcnt vmcnt(11)
    v_mfma_f32_16x16x32_bf16 v[20:23], v[76:79], a[176:179], v[20:23]
    buffer_load_dwordx4 v[124:127], v1, s[4:7], s80 offen offset:3072 sc1
    v_mfma_f32_16x16x32_bf16 v[208:211], v[76:79], a[180:183], v[208:211]
    v_mfma_f32_16x16x32_bf16 v[212:215], v[76:79], a[184:187], v[212:215]
    v_mfma_f32_16x16x32_bf16 v[216:219], v[76:79], a[188:191], v[216:219]
    s_waitcnt vmcnt(11)
    v_mfma_f32_16x16x32_bf16 v[20:23], v[80:83], a[192:195], v[20:23]
    s_add_u32 s80, s36, 40960
    buffer_load_dwordx4 v[128:131], v1, s[4:7], s80 offen offset:0 sc1
    v_mfma_f32_16x16x32_bf16 v[208:211], v[80:83], a[196:199], v[208:211]
    v_mfma_f32_16x16x32_bf16 v[212:215], v[80:83], a[200:203], v[212:215]
    v_mfma_f32_16x16x32_bf16 v[216:219], v[80:83], a[204:207], v[216:219]
    s_waitcnt vmcnt(11)
    v_mfma_f32_16x16x32_bf16 v[20:23], v[84:87], a[208:211], v[20:23]
    buffer_load_dwordx4 v[132:135], v1, s[4:7], s80 offen offset:1024 sc1
    v_mfma_f32_16x16x32_bf16 v[208:211], v[84:87], a[212:215], v[208:211]
    v_mfma_f32_16x16x32_bf16 v[212:215], v[84:87], a[216:219], v[212:215]
    v_mfma_f32_16x16x32_bf16 v[216:219], v[84:87], a[220:223], v[216:219]
    s_waitcnt vmcnt(11)
    v_mfma_f32_16x16x32_bf16 v[20:23], v[88:91], a[224:227], v[20:23]
    buffer_load_dwordx4 v[136:139], v1, s[4:7], s80 offen offset:2048 sc1
    v_mfma_f32_16x16x32_bf16 v[208:211], v[88:91], a[228:231], v[208:211]
    v_mfma_f32_16x16x32_bf16 v[212:215], v[88:91], a[232:235], v[212:215]
    v_mfma_f32_16x16x32_bf16 v[216:219], v[88:91], a[236:239], v[216:219]
    s_waitcnt vmcnt(11)
    v_mfma_f32_16x16x32_bf16 v[20:23], v[92:95], a[240:243], v[20:23]
    buffer_load_dwordx4 v[140:143], v1, s[4:7], s80 offen offset:3072 sc1
    v_mfma_f32_16x16x32_bf16 v[208:211], v[92:95], a[244:247], v[208:211]
    v_mfma_f32_16x16x32_bf16 v[212:215], v[92:95], a[248:251], v[212:215]
    v_mfma_f32_16x16x32_bf16 v[216:219], v[92:95], a[252:255], v[216:219]
    s_waitcnt vmcnt(11)
    v_mfma_f32_16x16x32_bf16 v[24:27], v[96:99], a[0:3], v[56:59]
    s_add_u32 s80, s36, 45056
    buffer_load_dwordx4 v[144:147], v1, s[4:7], s80 offen offset:0 sc1
    v_mfma_f32_16x16x32_bf16 v[196:199], v[96:99], a[4:7], 0
    v_mfma_f32_16x16x32_bf16 v[200:203], v[96:99], a[8:11], 0
    v_mfma_f32_16x16x32_bf16 v[204:207], v[96:99], a[12:15], 0
    s_waitcnt vmcnt(11)
    ds_write_b128 v235, v[208:211] offset:12288
    v_mfma_f32_16x16x32_bf16 v[24:27], v[100:103], a[16:19], v[24:27]
    buffer_load_dwordx4 v[148:151], v1, s[4:7], s80 offen offset:1024 sc1
    v_mfma_f32_16x16x32_bf16 v[196:199], v[100:103], a[20:23], v[196:199]
    v_mfma_f32_16x16x32_bf16 v[200:203], v[100:103], a[24:27], v[200:203]
    ds_write_b128 v236, v[212:215] offset:12288
    v_mfma_f32_16x16x32_bf16 v[204:207], v[100:103], a[28:31], v[204:207]
    s_waitcnt vmcnt(11)
    v_mfma_f32_16x16x32_bf16 v[24:27], v[104:107], a[32:35], v[24:27]
    buffer_load_dwordx4 v[152:155], v1, s[4:7], s80 offen offset:2048 sc1
    v_mfma_f32_16x16x32_bf16 v[196:199], v[104:107], a[36:39], v[196:199]
    ds_write_b128 v237, v[216:219] offset:12288
    v_mfma_f32_16x16x32_bf16 v[200:203], v[104:107], a[40:43], v[200:203]
    v_mfma_f32_16x16x32_bf16 v[204:207], v[104:107], a[44:47], v[204:207]
    s_waitcnt vmcnt(11)
    v_mfma_f32_16x16x32_bf16 v[24:27], v[108:111], a[48:51], v[24:27]
    buffer_load_dwordx4 v[156:159], v1, s[4:7], s80 offen offset:3072 sc1
    v_mfma_f32_16x16x32_bf16 v[196:199], v[108:111], a[52:55], v[196:199]
    v_mfma_f32_16x16x32_bf16 v[200:203], v[108:111], a[56:59], v[200:203]
    v_mfma_f32_16x16x32_bf16 v[204:207], v[108:111], a[60:63], v[204:207]
    s_waitcnt vmcnt(11)
    s_waitcnt lgkmcnt(0)
    s_barrier
    v_mfma_f32_16x16x32_bf16 v[24:27], v[112:115], a[64:67], v[24:27]
    s_add_u32 s80, s36, 49152
    buffer_load_dwordx4 v[64:67], v1, s[4:7], s80 offen offset:0 sc1
    ds_read_b128 v[188:191], v238 offset:12288
    v_mfma_f32_16x16x32_bf16 v[196:199], v[112:115], a[68:71], v[196:199]
    ds_read_b128 v[192:195], v238 offset:13312
    v_mfma_f32_16x16x32_bf16 v[200:203], v[112:115], a[72:75], v[200:203]
    ds_read_b128 v[52:55], v238 offset:14336
    v_mfma_f32_16x16x32_bf16 v[204:207], v[112:115], a[76:79], v[204:207]
    s_waitcnt vmcnt(11)
    v_mfma_f32_16x16x32_bf16 v[24:27], v[116:119], a[80:83], v[24:27]
    buffer_load_dwordx4 v[68:71], v1, s[4:7], s80 offen offset:1024 sc1
    v_mfma_f32_16x16x32_bf16 v[196:199], v[116:119], a[84:87], v[196:199]
    v_mfma_f32_16x16x32_bf16 v[200:203], v[116:119], a[88:91], v[200:203]
    v_mfma_f32_16x16x32_bf16 v[204:207], v[116:119], a[92:95], v[204:207]
    s_waitcnt vmcnt(11)
    s_waitcnt lgkmcnt(0)
    v_mfma_f32_16x16x32_bf16 v[24:27], v[120:123], a[96:99], v[24:27]
    buffer_load_dwordx4 v[72:75], v1, s[4:7], s80 offen offset:2048 sc1
    v_add_f32 v188, v188, v192
    v_mfma_f32_16x16x32_bf16 v[196:199], v[120:123], a[100:103], v[196:199]
    v_add_f32 v20, v20, v52
    v_mfma_f32_16x16x32_bf16 v[200:203], v[120:123], a[104:107], v[200:203]
    v_add_f32 v189, v189, v193
    v_mfma_f32_16x16x32_bf16 v[204:207], v[120:123], a[108:111], v[204:207]
    s_waitcnt vmcnt(11)
    v_add_f32 v21, v21, v53
    v_mfma_f32_16x16x32_bf16 v[24:27], v[124:127], a[112:115], v[24:27]
    buffer_load_dwordx4 v[76:79], v1, s[4:7], s80 offen offset:3072 sc1
    v_add_f32 v190, v190, v194
    v_mfma_f32_16x16x32_bf16 v[196:199], v[124:127], a[116:119], v[196:199]
    v_add_f32 v22, v22, v54
    v_mfma_f32_16x16x32_bf16 v[200:203], v[124:127], a[120:123], v[200:203]
    v_add_f32 v191, v191, v195
    v_mfma_f32_16x16x32_bf16 v[204:207], v[124:127], a[124:127], v[204:207]
    s_waitcnt vmcnt(11)
    v_add_f32 v23, v23, v55
    v_mfma_f32_16x16x32_bf16 v[24:27], v[128:131], a[128:131], v[24:27]
    s_add_u32 s80, s36, 53248
    buffer_load_dwordx4 v[80:83], v1, s[4:7], s80 offen offset:0 sc1
    v_add_f32 v188, v188, v20
    v_mfma_f32_16x16x32_bf16 v[196:199], v[128:131], a[132:135], v[196:199]
    v_add_f32 v189, v189, v21
    v_mfma_f32_16x16x32_bf16 v[200:203], v[128:131], a[136:139], v[200:203]
    v_add_f32 v190, v190, v22
    v_mfma_f32_16x16x32_bf16 v[204:207], v[128:131], a[140:143], v[204:207]
    s_waitcnt vmcnt(11)
    v_add_f32 v191, v191, v23
    v_mfma_f32_16x16x32_bf16 v[24:27], v[132:135], a[144:147], v[24:27]
    buffer_load_dwordx4 v[84:87], v1, s[4:7], s80 offen offset:1024 sc1
    v_mul_f32 v188, v188, v164
    v_mfma_f32_16x16x32_bf16 v[196:199], v[132:135], a[148:151], v[196:199]
    v_mul_f32 v189, v189, v165
    v_mfma_f32_16x16x32_bf16 v[200:203], v[132:135], a[152:155], v[200:203]
    v_mul_f32 v190, v190, v166
    v_mfma_f32_16x16x32_bf16 v[204:207], v[132:135], a[156:159], v[204:207]
    s_waitcnt vmcnt(11)
    v_mul_f32 v191, v191, v167
    v_mfma_f32_16x16x32_bf16 v[24:27], v[136:139], a[160:163], v[24:27]
    buffer_load_dwordx4 v[88:91], v1, s[4:7], s80 offen offset:2048 sc1
    v_cvt_pk_bf16_f32 v222, v188, v189
    v_mfma_f32_16x16x32_bf16 v[196:199], v[136:139], a[164:167], v[196:199]
    v_cvt_pk_bf16_f32 v223, v190, v191
    v_mfma_f32_16x16x32_bf16 v[200:203], v[136:139], a[168:171], v[200:203]
    s_add_u32 s81, s38, 0
    v_mfma_f32_16x16x32_bf16 v[204:207], v[136:139], a[172:175], v[204:207]
    s_waitcnt vmcnt(11)
    buffer_store_dwordx4 v[220:223], v1, s[4:7], s81 offen
    v_mfma_f32_16x16x32_bf16 v[24:27], v[140:143], a[176:179], v[24:27]
    buffer_load_dwordx4 v[92:95], v1, s[4:7], s80 offen offset:3072 sc1
    v_mfma_f32_16x16x32_bf16 v[196:199], v[140:143], a[180:183], v[196:199]
    v_mfma_f32_16x16x32_bf16 v[200:203], v[140:143], a[184:187], v[200:203]
    v_mfma_f32_16x16x32_bf16 v[204:207], v[140:143], a[188:191], v[204:207]
    s_waitcnt vmcnt(12)
    v_mfma_f32_16x16x32_bf16 v[24:27], v[144:147], a[192:195], v[24:27]
    s_add_u32 s80, s36, 57344
    buffer_load_dwordx4 v[96:99], v1, s[4:7], s80 offen offset:0 sc1
    v_mfma_f32_16x16x32_bf16 v[196:199], v[144:147], a[196:199], v[196:199]
    v_mfma_f32_16x16x32_bf16 v[200:203], v[144:147], a[200:203], v[200:203]
    v_mfma_f32_16x16x32_bf16 v[204:207], v[144:147], a[204:207], v[204:207]
    s_waitcnt vmcnt(12)
    v_mfma_f32_16x16x32_bf16 v[24:27], v[148:151], a[208:211], v[24:27]
    buffer_load_dwordx4 v[100:103], v1, s[4:7], s80 offen offset:1024 sc1
    v_mfma_f32_16x16x32_bf16 v[196:199], v[148:151], a[212:215], v[196:199]
    v_mfma_f32_16x16x32_bf16 v[200:203], v[148:151], a[216:219], v[200:203]
    v_mfma_f32_16x16x32_bf16 v[204:207], v[148:151], a[220:223], v[204:207]
    s_waitcnt vmcnt(12)
    v_mfma_f32_16x16x32_bf16 v[24:27], v[152:155], a[224:227], v[24:27]
    buffer_load_dwordx4 v[104:107], v1, s[4:7], s80 offen offset:2048 sc1
    v_mfma_f32_16x16x32_bf16 v[196:199], v[152:155], a[228:231], v[196:199]
    v_mfma_f32_16x16x32_bf16 v[200:203], v[152:155], a[232:235], v[200:203]
    v_mfma_f32_16x16x32_bf16 v[204:207], v[152:155], a[236:239], v[204:207]
    s_waitcnt vmcnt(12)
    v_mfma_f32_16x16x32_bf16 v[24:27], v[156:159], a[240:243], v[24:27]
    buffer_load_dwordx4 v[108:111], v1, s[4:7], s80 offen offset:3072 sc1
    v_mfma_f32_16x16x32_bf16 v[196:199], v[156:159], a[244:247], v[196:199]
    v_mfma_f32_16x16x32_bf16 v[200:203], v[156:159], a[248:251], v[200:203]
    v_mfma_f32_16x16x32_bf16 v[204:207], v[156:159], a[252:255], v[204:207]
    s_waitcnt vmcnt(12)
    v_mfma_f32_16x16x32_bf16 v[28:31], v[64:67], a[0:3], v[56:59]
    s_add_u32 s80, s36, 61440
    buffer_load_dwordx4 v[112:115], v1, s[4:7], s80 offen offset:0 sc1
    v_mfma_f32_16x16x32_bf16 v[208:211], v[64:67], a[4:7], 0
    v_mfma_f32_16x16x32_bf16 v[212:215], v[64:67], a[8:11], 0
    v_mfma_f32_16x16x32_bf16 v[216:219], v[64:67], a[12:15], 0
    s_waitcnt vmcnt(12)
    ds_write_b128 v235, v[196:199] offset:0
    v_mfma_f32_16x16x32_bf16 v[28:31], v[68:71], a[16:19], v[28:31]
    buffer_load_dwordx4 v[116:119], v1, s[4:7], s80 offen offset:1024 sc1
    v_mfma_f32_16x16x32_bf16 v[208:211], v[68:71], a[20:23], v[208:211]
    v_mfma_f32_16x16x32_bf16 v[212:215], v[68:71], a[24:27], v[212:215]
    ds_write_b128 v236, v[200:203] offset:0
    v_mfma_f32_16x16x32_bf16 v[216:219], v[68:71], a[28:31], v[216:219]
    s_waitcnt vmcnt(12)
    v_mfma_f32_16x16x32_bf16 v[28:31], v[72:75], a[32:35], v[28:31]
    buffer_load_dwordx4 v[120:123], v1, s[4:7], s80 offen offset:2048 sc1
    v_mfma_f32_16x16x32_bf16 v[208:211], v[72:75], a[36:39], v[208:211]
    ds_write_b128 v237, v[204:207] offset:0
    v_mfma_f32_16x16x32_bf16 v[212:215], v[72:75], a[40:43], v[212:215]
    v_mfma_f32_16x16x32_bf16 v[216:219], v[72:75], a[44:47], v[216:219]
    s_waitcnt vmcnt(12)
    v_mfma_f32_16x16x32_bf16 v[28:31], v[76:79], a[48:51], v[28:31]
    buffer_load_dwordx4 v[124:127], v1, s[4:7], s80 offen offset:3072 sc1
    v_mfma_f32_16x16x32_bf16 v[208:211], v[76:79], a[52:55], v[208:211]
    v_mfma_f32_16x16x32_bf16 v[212:215], v[76:79], a[56:59], v[212:215]
    v_mfma_f32_16x16x32_bf16 v[216:219], v[76:79], a[60:63], v[216:219]
    s_waitcnt vmcnt(12)
    s_waitcnt lgkmcnt(0)
    s_barrier
    v_mfma_f32_16x16x32_bf16 v[28:31], v[80:83], a[64:67], v[28:31]
    s_add_u32 s80, s36, 65536
    buffer_load_dwordx4 v[128:131], v1, s[4:7], s80 offen offset:0 sc1
    ds_read_b128 v[188:191], v238 offset:0
    v_mfma_f32_16x16x32_bf16 v[208:211], v[80:83], a[68:71], v[208:211]
    ds_read_b128 v[192:195], v238 offset:1024
    v_mfma_f32_16x16x32_bf16 v[212:215], v[80:83], a[72:75], v[212:215]
    ds_read_b128 v[52:55], v238 offset:2048
    v_mfma_f32_16x16x32_bf16 v[216:219], v[80:83], a[76:79], v[216:219]
    s_waitcnt vmcnt(12)
    v_mfma_f32_16x16x32_bf16 v[28:31], v[84:87], a[80:83], v[28:31]
    buffer_load_dwordx4 v[132:135], v1, s[4:7], s80 offen offset:1024 sc1
    v_mfma_f32_16x16x32_bf16 v[208:211], v[84:87], a[84:87], v[208:211]
    v_mfma_f32_16x16x32_bf16 v[212:215], v[84:87], a[88:91], v[212:215]
    v_mfma_f32_16x16x32_bf16 v[216:219], v[84:87], a[92:95], v[216:219]
    s_waitcnt vmcnt(12)
    s_waitcnt lgkmcnt(0)
    v_mfma_f32_16x16x32_bf16 v[28:31], v[88:91], a[96:99], v[28:31]
    buffer_load_dwordx4 v[136:139], v1, s[4:7], s80 offen offset:2048 sc1
    v_add_f32 v188, v188, v192
    v_mfma_f32_16x16x32_bf16 v[208:211], v[88:91], a[100:103], v[208:211]
    v_add_f32 v24, v24, v52
    v_mfma_f32_16x16x32_bf16 v[212:215], v[88:91], a[104:107], v[212:215]
    v_add_f32 v189, v189, v193
    v_mfma_f32_16x16x32_bf16 v[216:219], v[88:91], a[108:111], v[216:219]
    s_waitcnt vmcnt(11)
    v_add_f32 v25, v25, v53
    v_mfma_f32_16x16x32_bf16 v[28:31], v[92:95], a[112:115], v[28:31]
    s_add_u32 s77, s77, 0x101
    buffer_load_dwordx4 v[140:143], v1, s[4:7], s80 offen offset:3072 sc1
    v_add_f32 v190, v190, v194
    v_mfma_f32_16x16x32_bf16 v[208:211], v[92:95], a[116:119], v[208:211]
    v_add_f32 v26, v26, v54
    v_mov_b32 v251, s77
    v_mfma_f32_16x16x32_bf16 v[212:215], v[92:95], a[120:123], v[212:215]
    v_add_f32 v191, v191, v195
    s_waitcnt vmcnt(13)
    s_mov_b64 exec, 1
    buffer_store_short v251, off, s[4:7], s43 offset:64
    s_mov_b64 exec, -1
    v_mfma_f32_16x16x32_bf16 v[216:219], v[92:95], a[124:127], v[216:219]
    s_waitcnt vmcnt(12)
    v_add_f32 v27, v27, v55
    v_mfma_f32_16x16x32_bf16 v[28:31], v[96:99], a[128:131], v[28:31]
    s_add_u32 s80, s36, 69632
    buffer_load_dwordx4 v[144:147], v1, s[4:7], s80 offen offset:0 sc1
    v_add_f32 v188, v188, v24
    v_mfma_f32_16x16x32_bf16 v[208:211], v[96:99], a[132:135], v[208:211]
    v_add_f32 v189, v189, v25
    v_mfma_f32_16x16x32_bf16 v[212:215], v[96:99], a[136:139], v[212:215]
    v_add_f32 v190, v190, v26
    v_mfma_f32_16x16x32_bf16 v[216:219], v[96:99], a[140:143], v[216:219]
    s_waitcnt vmcnt(12)
    v_add_f32 v191, v191, v27
    v_mfma_f32_16x16x32_bf16 v[28:31], v[100:103], a[144:147], v[28:31]
    buffer_load_dwordx4 v[148:151], v1, s[4:7], s80 offen offset:1024 sc1
    v_mul_f32 v188, v188, v168
    v_mfma_f32_16x16x32_bf16 v[208:211], v[100:103], a[148:151], v[208:211]
    v_mul_f32 v189, v189, v169
    v_mfma_f32_16x16x32_bf16 v[212:215], v[100:103], a[152:155], v[212:215]
    v_mul_f32 v190, v190, v170
    v_mfma_f32_16x16x32_bf16 v[216:219], v[100:103], a[156:159], v[216:219]
    s_waitcnt vmcnt(12)
    v_mul_f32 v191, v191, v171
    v_mfma_f32_16x16x32_bf16 v[28:31], v[104:107], a[160:163], v[28:31]
    buffer_load_dwordx4 v[152:155], v1, s[4:7], s80 offen offset:2048 sc1
    v_cvt_pk_bf16_f32 v224, v188, v189
    v_mfma_f32_16x16x32_bf16 v[208:211], v[104:107], a[164:167], v[208:211]
    v_cvt_pk_bf16_f32 v225, v190, v191
    v_mfma_f32_16x16x32_bf16 v[212:215], v[104:107], a[168:171], v[212:215]
    v_mfma_f32_16x16x32_bf16 v[216:219], v[104:107], a[172:175], v[216:219]
    s_waitcnt vmcnt(12)
    v_mfma_f32_16x16x32_bf16 v[28:31], v[108:111], a[176:179], v[28:31]
    buffer_load_dwordx4 v[156:159], v1, s[4:7], s80 offen offset:3072 sc1
    v_mfma_f32_16x16x32_bf16 v[208:211], v[108:111], a[180:183], v[208:211]
    v_mfma_f32_16x16x32_bf16 v[212:215], v[108:111], a[184:187], v[212:215]
    v_mfma_f32_16x16x32_bf16 v[216:219], v[108:111], a[188:191], v[216:219]
    s_waitcnt vmcnt(12)
    v_mfma_f32_16x16x32_bf16 v[28:31], v[112:115], a[192:195], v[28:31]
    s_add_u32 s80, s36, 73728
    buffer_load_dwordx4 v[64:67], v1, s[4:7], s80 offen offset:0 sc1
    v_mfma_f32_16x16x32_bf16 v[208:211], v[112:115], a[196:199], v[208:211]
    v_mfma_f32_16x16x32_bf16 v[212:215], v[112:115], a[200:203], v[212:215]
    v_mfma_f32_16x16x32_bf16 v[216:219], v[112:115], a[204:207], v[216:219]
    s_waitcnt vmcnt(12)
    v_mfma_f32_16x16x32_bf16 v[28:31], v[116:119], a[208:211], v[28:31]
    buffer_load_dwordx4 v[68:71], v1, s[4:7], s80 offen offset:1024 sc1
    v_mfma_f32_16x16x32_bf16 v[208:211], v[116:119], a[212:215], v[208:211]
    v_mfma_f32_16x16x32_bf16 v[212:215], v[116:119], a[216:219], v[212:215]
    v_mfma_f32_16x16x32_bf16 v[216:219], v[116:119], a[220:223], v[216:219]
    s_waitcnt vmcnt(12)
    v_mfma_f32_16x16x32_bf16 v[28:31], v[120:123], a[224:227], v[28:31]
    buffer_load_dwordx4 v[72:75], v1, s[4:7], s80 offen offset:2048 sc1
    v_mfma_f32_16x16x32_bf16 v[208:211], v[120:123], a[228:231], v[208:211]
    v_mfma_f32_16x16x32_bf16 v[212:215], v[120:123], a[232:235], v[212:215]
    v_mfma_f32_16x16x32_bf16 v[216:219], v[120:123], a[236:239], v[216:219]
    s_waitcnt vmcnt(12)
    v_mfma_f32_16x16x32_bf16 v[28:31], v[124:127], a[240:243], v[28:31]
    buffer_load_dwordx4 v[76:79], v1, s[4:7], s80 offen offset:3072 sc1
    v_mfma_f32_16x16x32_bf16 v[208:211], v[124:127], a[244:247], v[208:211]
    v_mfma_f32_16x16x32_bf16 v[212:215], v[124:127], a[248:251], v[212:215]
    v_mfma_f32_16x16x32_bf16 v[216:219], v[124:127], a[252:255], v[216:219]
    s_waitcnt vmcnt(12)
    v_mfma_f32_16x16x32_bf16 v[32:35], v[128:131], a[0:3], v[56:59]
    s_add_u32 s80, s36, 77824
    buffer_load_dwordx4 v[80:83], v1, s[4:7], s80 offen offset:0 sc1
    s_cmp_lg_u32 s66, 0
    s_cbranch_scc1 L_skip_27
    global_load_dword v254, v240, s[0:1]
L_skip_27:
    v_mfma_f32_16x16x32_bf16 v[196:199], v[128:131], a[4:7], 0
    v_mfma_f32_16x16x32_bf16 v[200:203], v[128:131], a[8:11], 0
    v_mfma_f32_16x16x32_bf16 v[204:207], v[128:131], a[12:15], 0
    s_waitcnt vmcnt(12)
    ds_write_b128 v235, v[208:211] offset:12288
    v_mfma_f32_16x16x32_bf16 v[32:35], v[132:135], a[16:19], v[32:35]
    buffer_load_dwordx4 v[84:87], v1, s[4:7], s80 offen offset:1024 sc1
    v_mfma_f32_16x16x32_bf16 v[196:199], v[132:135], a[20:23], v[196:199]
    v_mfma_f32_16x16x32_bf16 v[200:203], v[132:135], a[24:27], v[200:203]
    ds_write_b128 v236, v[212:215] offset:12288
    v_mfma_f32_16x16x32_bf16 v[204:207], v[132:135], a[28:31], v[204:207]
    s_waitcnt vmcnt(12)
    v_mfma_f32_16x16x32_bf16 v[32:35], v[136:139], a[32:35], v[32:35]
    buffer_load_dwordx4 v[88:91], v1, s[4:7], s80 offen offset:2048 sc1
    v_mfma_f32_16x16x32_bf16 v[196:199], v[136:139], a[36:39], v[196:199]
    ds_write_b128 v237, v[216:219] offset:12288
    v_mfma_f32_16x16x32_bf16 v[200:203], v[136:139], a[40:43], v[200:203]
    v_mfma_f32_16x16x32_bf16 v[204:207], v[136:139], a[44:47], v[204:207]
    s_waitcnt vmcnt(12)
    v_mfma_f32_16x16x32_bf16 v[32:35], v[140:143], a[48:51], v[32:35]
    buffer_load_dwordx4 v[92:95], v1, s[4:7], s80 offen offset:3072 sc1
    v_mfma_f32_16x16x32_bf16 v[196:199], v[140:143], a[52:55], v[196:199]
    v_mfma_f32_16x16x32_bf16 v[200:203], v[140:143], a[56:59], v[200:203]
    v_mfma_f32_16x16x32_bf16 v[204:207], v[140:143], a[60:63], v[204:207]
    s_waitcnt vmcnt(11)
    s_waitcnt lgkmcnt(0)
    s_barrier
    v_mfma_f32_16x16x32_bf16 v[32:35], v[144:147], a[64:67], v[32:35]
    s_add_u32 s80, s36, 81920
    buffer_load_dwordx4 v[96:99], v1, s[4:7], s80 offen offset:0 sc1
    ds_read_b128 v[188:191], v238 offset:12288
    v_mfma_f32_16x16x32_bf16 v[196:199], v[144:147], a[68:71], v[196:199]
    ds_read_b128 v[192:195], v238 offset:13312
    v_mfma_f32_16x16x32_bf16 v[200:203], v[144:147], a[72:75], v[200:203]
    ds_read_b128 v[52:55], v238 offset:14336
    v_mfma_f32_16x16x32_bf16 v[204:207], v[144:147], a[76:79], v[204:207]
    s_waitcnt vmcnt(11)
    v_mfma_f32_16x16x32_bf16 v[32:35], v[148:151], a[80:83], v[32:35]
    buffer_load_dwordx4 v[100:103], v1, s[4:7], s80 offen offset:1024 sc1
    v_mfma_f32_16x16x32_bf16 v[196:199], v[148:151], a[84:87], v[196:199]
    v_mfma_f32_16x16x32_bf16 v[200:203], v[148:151], a[88:91], v[200:203]
    v_mfma_f32_16x16x32_bf16 v[204:207], v[148:151], a[92:95], v[204:207]
    s_waitcnt vmcnt(11)
    s_waitcnt lgkmcnt(0)
    v_mfma_f32_16x16x32_bf16 v[32:35], v[152:155], a[96:99], v[32:35]
    buffer_load_dwordx4 v[104:107], v1, s[4:7], s80 offen offset:2048 sc1
    v_add_f32 v188, v188, v192
    v_mfma_f32_16x16x32_bf16 v[196:199], v[152:155], a[100:103], v[196:199]
    v_add_f32 v28, v28, v52
    v_mfma_f32_16x16x32_bf16 v[200:203], v[152:155], a[104:107], v[200:203]
    v_add_f32 v189, v189, v193
    v_mfma_f32_16x16x32_bf16 v[204:207], v[152:155], a[108:111], v[204:207]
    s_waitcnt vmcnt(11)
    v_add_f32 v29, v29, v53
    v_mfma_f32_16x16x32_bf16 v[32:35], v[156:159], a[112:115], v[32:35]
    buffer_load_dwordx4 v[108:111], v1, s[4:7], s80 offen offset:3072 sc1
    v_add_f32 v190, v190, v194
    v_mfma_f32_16x16x32_bf16 v[196:199], v[156:159], a[116:119], v[196:199]
    v_add_f32 v30, v30, v54
    v_mfma_f32_16x16x32_bf16 v[200:203], v[156:159], a[120:123], v[200:203]
    v_add_f32 v191, v191, v195
    v_mfma_f32_16x16x32_bf16 v[204:207], v[156:159], a[124:127], v[204:207]
    s_waitcnt vmcnt(11)
    v_add_f32 v31, v31, v55
    v_mfma_f32_16x16x32_bf16 v[32:35], v[64:67], a[128:131], v[32:35]
    s_add_u32 s80, s36, 86016
    buffer_load_dwordx4 v[112:115], v1, s[4:7], s80 offen offset:0 sc1
    v_add_f32 v188, v188, v28
    v_mfma_f32_16x16x32_bf16 v[196:199], v[64:67], a[132:135], v[196:199]
    v_add_f32 v189, v189, v29
    v_mfma_f32_16x16x32_bf16 v[200:203], v[64:67], a[136:139], v[200:203]
    v_add_f32 v190, v190, v30
    v_mfma_f32_16x16x32_bf16 v[204:207], v[64:67], a[140:143], v[204:207]
    s_waitcnt vmcnt(11)
    v_add_f32 v191, v191, v31
    v_mfma_f32_16x16x32_bf16 v[32:35], v[68:71], a[144:147], v[32:35]
    buffer_load_dwordx4 v[116:119], v1, s[4:7], s80 offen offset:1024 sc1
    v_mul_f32 v188, v188, v172
    v_mfma_f32_16x16x32_bf16 v[196:199], v[68:71], a[148:151], v[196:199]
    v_mul_f32 v189, v189, v173
    v_mfma_f32_16x16x32_bf16 v[200:203], v[68:71], a[152:155], v[200:203]
    v_mul_f32 v190, v190, v174
    v_mfma_f32_16x16x32_bf16 v[204:207], v[68:71], a[156:159], v[204:207]
    s_waitcnt vmcnt(11)
    v_mul_f32 v191, v191, v175
    v_mfma_f32_16x16x32_bf16 v[32:35], v[72:75], a[160:163], v[32:35]
    buffer_load_dwordx4 v[120:123], v1, s[4:7], s80 offen offset:2048 sc1
    v_cvt_pk_bf16_f32 v226, v188, v189
    v_mfma_f32_16x16x32_bf16 v[196:199], v[72:75], a[164:167], v[196:199]
    v_cvt_pk_bf16_f32 v227, v190, v191
    v_mfma_f32_16x16x32_bf16 v[200:203], v[72:75], a[168:171], v[200:203]
    s_add_u32 s81, s38, 8192
    v_mfma_f32_16x16x32_bf16 v[204:207], v[72:75], a[172:175], v[204:207]
    s_waitcnt vmcnt(11)
    buffer_store_dwordx4 v[224:227], v1, s[4:7], s81 offen
    v_mfma_f32_16x16x32_bf16 v[32:35], v[76:79], a[176:179], v[32:35]
    s_mul_i32 s83, s65, 1536
    buffer_load_dwordx4 v[124:127], v1, s[4:7], s80 offen offset:3072 sc1
    s_add_u32 s83, s83, s40
    v_mfma_f32_16x16x32_bf16 v[196:199], v[76:79], a[180:183], v[196:199]
    v_lshlrev_b32 v12, 7, v0
    v_mfma_f32_16x16x32_bf16 v[200:203], v[76:79], a[184:187], v[200:203]
    v_add_u32 v13, s83, v12
    v_mfma_f32_16x16x32_bf16 v[204:207], v[76:79], a[188:191], v[204:207]
    s_waitcnt vmcnt(12)
    v_and_b32 v12, 128, v12
    v_mfma_f32_16x16x32_bf16 v[32:35], v[80:83], a[192:195], v[32:35]
    s_add_u32 s80, s36, 90112
    buffer_load_dwordx4 v[128:131], v1, s[4:7], s80 offen offset:0 sc1
    v_add_u32 v12, s42, v12
    v_mfma_f32_16x16x32_bf16 v[196:199], v[80:83], a[196:199], v[196:199]
    v_cmp_gt_u32 vcc, 12, v0
    s_nop 1
    v_cndmask_b32 v12, v12, v13, vcc
    v_mfma_f32_16x16x32_bf16 v[200:203], v[80:83], a[200:203], v[200:203]
    v_mfma_f32_16x16x32_bf16 v[204:207], v[80:83], a[204:207], v[204:207]
    s_waitcnt vmcnt(12)
    v_mfma_f32_16x16x32_bf16 v[32:35], v[84:87], a[208:211], v[32:35]
    buffer_load_dwordx4 v[132:135], v1, s[4:7], s80 offen offset:1024 sc1
    v_mfma_f32_16x16x32_bf16 v[196:199], v[84:87], a[212:215], v[196:199]
    v_mfma_f32_16x16x32_bf16 v[200:203], v[84:87], a[216:219], v[200:203]
    v_mfma_f32_16x16x32_bf16 v[204:207], v[84:87], a[220:223], v[204:207]
    s_waitcnt vmcnt(12)
    v_mfma_f32_16x16x32_bf16 v[32:35], v[88:91], a[224:227], v[32:35]
    buffer_load_dwordx4 v[136:139], v1, s[4:7], s80 offen offset:2048 sc1
    v_mfma_f32_16x16x32_bf16 v[196:199], v[88:91], a[228:231], v[196:199]
    v_mfma_f32_16x16x32_bf16 v[200:203], v[88:91], a[232:235], v[200:203]
    v_mfma_f32_16x16x32_bf16 v[204:207], v[88:91], a[236:239], v[204:207]
    s_waitcnt vmcnt(12)
    v_mfma_f32_16x16x32_bf16 v[32:35], v[92:95], a[240:243], v[32:35]
    buffer_load_dwordx4 v[140:143], v1, s[4:7], s80 offen offset:3072 sc1
    v_mfma_f32_16x16x32_bf16 v[196:199], v[92:95], a[244:247], v[196:199]
    v_mfma_f32_16x16x32_bf16 v[200:203], v[92:95], a[248:251], v[200:203]
    v_mfma_f32_16x16x32_bf16 v[204:207], v[92:95], a[252:255], v[204:207]
    s_waitcnt vmcnt(12)
    v_mfma_f32_16x16x32_bf16 v[36:39], v[96:99], a[0:3], v[56:59]
    s_add_u32 s80, s36, 94208
    buffer_load_dwordx4 v[144:147], v1, s[4:7], s80 offen offset:0 sc1
    v_mfma_f32_16x16x32_bf16 v[208:211], v[96:99], a[4:7], 0
    v_mfma_f32_16x16x32_bf16 v[212:215], v[96:99], a[8:11], 0
    v_mfma_f32_16x16x32_bf16 v[216:219], v[96:99], a[12:15], 0
    s_waitcnt vmcnt(12)
    ds_write_b128 v235, v[196:199] offset:0
    v_mfma_f32_16x16x32_bf16 v[36:39], v[100:103], a[16:19], v[36:39]
    buffer_load_dwordx4 v[148:151], v1, s[4:7], s80 offen offset:1024 sc1
    v_mfma_f32_16x16x32_bf16 v[208:211], v[100:103], a[20:23], v[208:211]
    v_mfma_f32_16x16x32_bf16 v[212:215], v[100:103], a[24:27], v[212:215]
    ds_write_b128 v236, v[200:203] offset:0
    v_mfma_f32_16x16x32_bf16 v[216:219], v[100:103], a[28:31], v[216:219]
    s_waitcnt vmcnt(12)
    v_mfma_f32_16x16x32_bf16 v[36:39], v[104:107], a[32:35], v[36:39]
    buffer_load_dwordx4 v[152:155], v1, s[4:7], s80 offen offset:2048 sc1
    v_mfma_f32_16x16x32_bf16 v[208:211], v[104:107], a[36:39], v[208:211]
    ds_write_b128 v237, v[204:207] offset:0
    v_mfma_f32_16x16x32_bf16 v[212:215], v[104:107], a[40:43], v[212:215]
    v_mfma_f32_16x16x32_bf16 v[216:219], v[104:107], a[44:47], v[216:219]
    s_waitcnt vmcnt(12)
    v_mfma_f32_16x16x32_bf16 v[36:39], v[108:111], a[48:51], v[36:39]
    buffer_load_dwordx4 v[156:159], v1, s[4:7], s80 offen offset:3072 sc1
    v_mfma_f32_16x16x32_bf16 v[208:211], v[108:111], a[52:55], v[208:211]
    v_mfma_f32_16x16x32_bf16 v[212:215], v[108:111], a[56:59], v[212:215]
    v_mfma_f32_16x16x32_bf16 v[216:219], v[108:111], a[60:63], v[216:219]
    s_waitcnt vmcnt(12)
    s_waitcnt lgkmcnt(0)
    s_barrier
    v_mfma_f32_16x16x32_bf16 v[36:39], v[112:115], a[64:67], v[36:39]
    s_add_u32 s80, s36, 98304
    buffer_load_dwordx4 v[64:67], v1, s[4:7], s80 offen offset:0 sc1
    ds_read_b128 v[188:191], v238 offset:0
    v_mfma_f32_16x16x32_bf16 v[208:211], v[112:115], a[68:71], v[208:211]
    buffer_load_ubyte v250, v2, s[4:7], s91 offen offset:64 sc1
    ds_read_b128 v[192:195], v238 offset:1024
    v_mfma_f32_16x16x32_bf16 v[212:215], v[112:115], a[72:75], v[212:215]
    ds_read_b128 v[52:55], v238 offset:2048
    v_mfma_f32_16x16x32_bf16 v[216:219], v[112:115], a[76:79], v[216:219]
    s_waitcnt vmcnt(13)
    v_mfma_f32_16x16x32_bf16 v[36:39], v[116:119], a[80:83], v[36:39]
    buffer_load_dwordx4 v[68:71], v1, s[4:7], s80 offen offset:1024 sc1
    v_mfma_f32_16x16x32_bf16 v[208:211], v[116:119], a[84:87], v[208:211]
    v_mfma_f32_16x16x32_bf16 v[212:215], v[116:119], a[88:91], v[212:215]
    v_mfma_f32_16x16x32_bf16 v[216:219], v[116:119], a[92:95], v[216:219]
    s_waitcnt vmcnt(13)
    s_waitcnt lgkmcnt(0)
    v_mfma_f32_16x16x32_bf16 v[36:39], v[120:123], a[96:99], v[36:39]
    buffer_load_dwordx4 v[72:75], v1, s[4:7], s80 offen offset:2048 sc1
    v_add_f32 v188, v188, v192
    v_mfma_f32_16x16x32_bf16 v[208:211], v[120:123], a[100:103], v[208:211]
    v_add_f32 v32, v32, v52
    v_mfma_f32_16x16x32_bf16 v[212:215], v[120:123], a[104:107], v[212:215]
    v_add_f32 v189, v189, v193
    v_mfma_f32_16x16x32_bf16 v[216:219], v[120:123], a[108:111], v[216:219]
    s_waitcnt vmcnt(12)
    v_add_f32 v33, v33, v53
    v_mfma_f32_16x16x32_bf16 v[36:39], v[124:127], a[112:115], v[36:39]
    s_add_u32 s77, s77, 0x101
    buffer_load_dwordx4 v[76:79], v1, s[4:7], s80 offen offset:3072 sc1
    v_add_f32 v190, v190, v194
    v_mfma_f32_16x16x32_bf16 v[208:211], v[124:127], a[116:119], v[208:211]
    v_add_f32 v34, v34, v54
    v_mov_b32 v251, s77
    v_mfma_f32_16x16x32_bf16 v[212:215], v[124:127], a[120:123], v[212:215]
    v_add_f32 v191, v191, v195
    s_waitcnt vmcnt(14)
    s_mov_b64 exec, 1
    buffer_store_short v251, off, s[4:7], s43 offset:64
    s_mov_b64 exec, -1
    v_mfma_f32_16x16x32_bf16 v[216:219], v[124:127], a[124:127], v[216:219]
    s_waitcnt vmcnt(13)
    v_add_f32 v35, v35, v55
    v_mfma_f32_16x16x32_bf16 v[36:39], v[128:131], a[128:131], v[36:39]
    s_add_u32 s80, s36, 102400
    buffer_load_dwordx4 v[80:83], v1, s[4:7], s80 offen offset:0 sc1
    v_add_f32 v188, v188, v32
    v_mfma_f32_16x16x32_bf16 v[208:211], v[128:131], a[132:135], v[208:211]
    v_add_f32 v189, v189, v33
    v_mfma_f32_16x16x32_bf16 v[212:215], v[128:131], a[136:139], v[212:215]
    v_add_f32 v190, v190, v34
    v_mfma_f32_16x16x32_bf16 v[216:219], v[128:131], a[140:143], v[216:219]
    s_waitcnt vmcnt(13)
    v_add_f32 v191, v191, v35
    v_mfma_f32_16x16x32_bf16 v[36:39], v[132:135], a[144:147], v[36:39]
    buffer_load_dwordx4 v[84:87], v1, s[4:7], s80 offen offset:1024 sc1
    v_mul_f32 v188, v188, v176
    v_mfma_f32_16x16x32_bf16 v[208:211], v[132:135], a[148:151], v[208:211]
    v_mul_f32 v189, v189, v177
    v_mfma_f32_16x16x32_bf16 v[212:215], v[132:135], a[152:155], v[212:215]
    v_mul_f32 v190, v190, v178
    v_mfma_f32_16x16x32_bf16 v[216:219], v[132:135], a[156:159], v[216:219]
    s_waitcnt vmcnt(13)
    v_mul_f32 v191, v191, v179
    v_mfma_f32_16x16x32_bf16 v[36:39], v[136:139], a[160:163], v[36:39]
    buffer_load_dwordx4 v[88:91], v1, s[4:7], s80 offen offset:2048 sc1
    v_cvt_pk_bf16_f32 v220, v188, v189
    v_mfma_f32_16x16x32_bf16 v[208:211], v[136:139], a[164:167], v[208:211]
    v_cvt_pk_bf16_f32 v221, v190, v191
    v_mfma_f32_16x16x32_bf16 v[212:215], v[136:139], a[168:171], v[212:215]
    v_mfma_f32_16x16x32_bf16 v[216:219], v[136:139], a[172:175], v[216:219]
    s_waitcnt vmcnt(13)
    v_mfma_f32_16x16x32_bf16 v[36:39], v[140:143], a[176:179], v[36:39]
    buffer_load_dwordx4 v[92:95], v1, s[4:7], s80 offen offset:3072 sc1
    v_mfma_f32_16x16x32_bf16 v[208:211], v[140:143], a[180:183], v[208:211]
    v_mfma_f32_16x16x32_bf16 v[212:215], v[140:143], a[184:187], v[212:215]
    v_mfma_f32_16x16x32_bf16 v[216:219], v[140:143], a[188:191], v[216:219]
    s_waitcnt vmcnt(13)
    v_mfma_f32_16x16x32_bf16 v[36:39], v[144:147], a[192:195], v[36:39]
    s_add_u32 s80, s36, 106496
    buffer_load_dwordx4 v[96:99], v1, s[4:7], s80 offen offset:0 sc1
    v_mfma_f32_16x16x32_bf16 v[208:211], v[144:147], a[196:199], v[208:211]
    v_mfma_f32_16x16x32_bf16 v[212:215], v[144:147], a[200:203], v[212:215]
    v_mfma_f32_16x16x32_bf16 v[216:219], v[144:147], a[204:207], v[216:219]
    s_waitcnt vmcnt(13)
    v_mfma_f32_16x16x32_bf16 v[36:39], v[148:151], a[208:211], v[36:39]
    buffer_load_dwordx4 v[100:103], v1, s[4:7], s80 offen offset:1024 sc1
    v_mfma_f32_16x16x32_bf16 v[208:211], v[148:151], a[212:215], v[208:211]
    v_mfma_f32_16x16x32_bf16 v[212:215], v[148:151], a[216:219], v[212:215]
    v_mfma_f32_16x16x32_bf16 v[216:219], v[148:151], a[220:223], v[216:219]
    s_waitcnt vmcnt(13)
    v_mfma_f32_16x16x32_bf16 v[36:39], v[152:155], a[224:227], v[36:39]
    buffer_load_dwordx4 v[104:107], v1, s[4:7], s80 offen offset:2048 sc1
    v_mfma_f32_16x16x32_bf16 v[208:211], v[152:155], a[228:231], v[208:211]
    v_mfma_f32_16x16x32_bf16 v[212:215], v[152:155], a[232:235], v[212:215]
    v_mfma_f32_16x16x32_bf16 v[216:219], v[152:155], a[236:239], v[216:219]
    s_waitcnt vmcnt(13)
    v_mfma_f32_16x16x32_bf16 v[36:39], v[156:159], a[240:243], v[36:39]
    buffer_load_dwordx4 v[108:111], v1, s[4:7], s80 offen offset:3072 sc1
    v_mfma_f32_16x16x32_bf16 v[208:211], v[156:159], a[244:247], v[208:211]
    v_mfma_f32_16x16x32_bf16 v[212:215], v[156:159], a[248:251], v[212:215]
    v_mfma_f32_16x16x32_bf16 v[216:219], v[156:159], a[252:255], v[216:219]
    s_waitcnt vmcnt(13)
    v_mfma_f32_16x16x32_bf16 v[40:43], v[64:67], a[0:3], v[56:59]
    s_add_u32 s80, s36, 110592
    buffer_load_dwordx4 v[112:115], v1, s[4:7], s80 offen offset:0 sc1
    v_lshlrev_b32 v16, 16, v44
    v_mfma_f32_16x16x32_bf16 v[196:199], v[64:67], a[4:7], 0
    s_lshl2_add_u32 s82, s66, 1
    s_waitcnt vmcnt(13)
    v_cmp_gt_u32 vcc, s82, v250
    s_cbranch_vccnz L_rt_28
L_bk_29:
    v_and_b32 v17, 0xffff0000, v44
    v_mfma_f32_16x16x32_bf16 v[200:203], v[64:67], a[8:11], 0
    buffer_load_ubyte v250, v2, s[4:7], s91 offen offset:64 sc1
    v_lshlrev_b32 v18, 16, v45
    v_mfma_f32_16x16x32_bf16 v[204:207], v[64:67], a[12:15], 0
    s_waitcnt vmcnt(13)
    ds_write_b128 v235, v[208:211] offset:12288
    v_and_b32 v19, 0xffff0000, v45
    v_mfma_f32_16x16x32_bf16 v[40:43], v[68:71], a[16:19], v[40:43]
    buffer_load_dwordx4 v[116:119], v1, s[4:7], s80 offen offset:1024 sc1
    v_lshlrev_b32 v20, 16, v46
    v_mfma_f32_16x16x32_bf16 v[196:199], v[68:71], a[20:23], v[196:199]
    v_and_b32 v21, 0xffff0000, v46
    v_mfma_f32_16x16x32_bf16 v[200:203], v[68:71], a[24:27], v[200:203]
    ds_write_b128 v236, v[212:215] offset:12288
    v_lshlrev_b32 v22, 16, v47
    v_mfma_f32_16x16x32_bf16 v[204:207], v[68:71], a[28:31], v[204:207]
    s_waitcnt vmcnt(13)
    v_and_b32 v23, 0xffff0000, v47
    v_mfma_f32_16x16x32_bf16 v[40:43], v[72:75], a[32:35], v[40:43]
    buffer_load_dwordx4 v[120:123], v1, s[4:7], s80 offen offset:2048 sc1
    v_lshlrev_b32 v24, 16, v48
    v_mfma_f32_16x16x32_bf16 v[196:199], v[72:75], a[36:39], v[196:199]
    ds_write_b128 v237, v[216:219] offset:12288
    v_and_b32 v25, 0xffff0000, v48
    v_mfma_f32_16x16x32_bf16 v[200:203], v[72:75], a[40:43], v[200:203]
    v_lshlrev_b32 v26, 16, v49
    v_mfma_f32_16x16x32_bf16 v[204:207], v[72:75], a[44:47], v[204:207]
    s_waitcnt vmcnt(13)
    v_and_b32 v27, 0xffff0000, v49
    v_mfma_f32_16x16x32_bf16 v[40:43], v[76:79], a[48:51], v[40:43]
    buffer_load_dwordx4 v[124:127], v1, s[4:7], s80 offen offset:3072 sc1
    v_lshlrev_b32 v28, 16, v50
    v_mfma_f32_16x16x32_bf16 v[196:199], v[76:79], a[52:55], v[196:199]
    v_and_b32 v29, 0xffff0000, v50
    v_mfma_f32_16x16x32_bf16 v[200:203], v[76:79], a[56:59], v[200:203]
    buffer_load_dword v254, v12, s[4:7], 0 offen offset:0
    v_lshlrev_b32 v30, 16, v51
    v_mfma_f32_16x16x32_bf16 v[204:207], v[76:79], a[60:63], v[204:207]
    s_waitcnt vmcnt(13)
    s_waitcnt lgkmcnt(0)
    s_barrier
    v_and_b32 v31, 0xffff0000, v51
    v_mfma_f32_16x16x32_bf16 v[40:43], v[80:83], a[64:67], v[40:43]
    s_add_u32 s80, s37, 0
    buffer_load_dwordx4 v[128:131], v1, s[4:7], s80 offen offset:0 sc1
    ds_read_b128 v[188:191], v238 offset:12288
    v_mfma_f32_16x16x32_bf16 v[196:199], v[80:83], a[68:71], v[196:199]
    ds_read_b128 v[192:195], v238 offset:13312
    v_mfma_f32_16x16x32_bf16 v[200:203], v[80:83], a[72:75], v[200:203]
    ds_read_b128 v[52:55], v238 offset:14336
    v_mfma_f32_16x16x32_bf16 v[204:207], v[80:83], a[76:79], v[204:207]
    s_waitcnt vmcnt(13)
    v_mfma_f32_16x16x32_bf16 v[40:43], v[84:87], a[80:83], v[40:43]
    buffer_load_dwordx4 v[132:135], v1, s[4:7], s80 offen offset:1024 sc1
    v_mfma_f32_16x16x32_bf16 v[196:199], v[84:87], a[84:87], v[196:199]
    v_mfma_f32_16x16x32_bf16 v[200:203], v[84:87], a[88:91], v[200:203]
    v_mfma_f32_16x16x32_bf16 v[204:207], v[84:87], a[92:95], v[204:207]
    s_waitcnt vmcnt(13)
    s_waitcnt lgkmcnt(0)
    v_mfma_f32_16x16x32_bf16 v[40:43], v[88:91], a[96:99], v[40:43]
    buffer_load_dwordx4 v[136:139], v1, s[4:7], s80 offen offset:2048 sc1
    v_add_f32 v188, v188, v192
    v_mfma_f32_16x16x32_bf16 v[196:199], v[88:91], a[100:103], v[196:199]
    v_add_f32 v36, v36, v52
    v_mfma_f32_16x16x32_bf16 v[200:203], v[88:91], a[104:107], v[200:203]
    v_add_f32 v189, v189, v193
    v_mfma_f32_16x16x32_bf16 v[204:207], v[88:91], a[108:111], v[204:207]
    s_waitcnt vmcnt(13)
    v_add_f32 v37, v37, v53
    v_mfma_f32_16x16x32_bf16 v[40:43], v[92:95], a[112:115], v[40:43]
    buffer_load_dwordx4 v[140:143], v1, s[4:7], s80 offen offset:3072 sc1
    v_add_f32 v190, v190, v194
    v_mfma_f32_16x16x32_bf16 v[196:199], v[92:95], a[116:119], v[196:199]
    v_add_f32 v38, v38, v54
    v_mfma_f32_16x16x32_bf16 v[200:203], v[92:95], a[120:123], v[200:203]
    v_add_f32 v191, v191, v195
    v_mfma_f32_16x16x32_bf16 v[204:207], v[92:95], a[124:127], v[204:207]
    s_waitcnt vmcnt(13)
    v_add_f32 v39, v39, v55
    v_mfma_f32_16x16x32_bf16 v[40:43], v[96:99], a[128:131], v[40:43]
    s_add_u32 s80, s37, 4096
    buffer_load_dwordx4 v[144:147], v1, s[4:7], s80 offen offset:0 sc1
    v_add_f32 v188, v188, v36
    v_mfma_f32_16x16x32_bf16 v[196:199], v[96:99], a[132:135], v[196:199]
    v_add_f32 v189, v189, v37
    v_mfma_f32_16x16x32_bf16 v[200:203], v[96:99], a[136:139], v[200:203]
    v_add_f32 v190, v190, v38
    v_mfma_f32_16x16x32_bf16 v[204:207], v[96:99], a[140:143], v[204:207]
    s_waitcnt vmcnt(13)
    v_add_f32 v191, v191, v39
    v_mfma_f32_16x16x32_bf16 v[40:43], v[100:103], a[144:147], v[40:43]
    buffer_load_dwordx4 v[148:151], v1, s[4:7], s80 offen offset:1024 sc1
    v_mul_f32 v188, v188, v180
    v_mfma_f32_16x16x32_bf16 v[196:199], v[100:103], a[148:151], v[196:199]
    v_mul_f32 v189, v189, v181
    v_mfma_f32_16x16x32_bf16 v[200:203], v[100:103], a[152:155], v[200:203]
    v_mul_f32 v190, v190, v182
    v_mfma_f32_16x16x32_bf16 v[204:207], v[100:103], a[156:159], v[204:207]
    s_waitcnt vmcnt(13)
    v_mul_f32 v191, v191, v183
    v_mfma_f32_16x16x32_bf16 v[40:43], v[104:107], a[160:163], v[40:43]
    buffer_load_dwordx4 v[152:155], v1, s[4:7], s80 offen offset:2048 sc1
    v_cvt_pk_bf16_f32 v222, v188, v189
    v_mfma_f32_16x16x32_bf16 v[196:199], v[104:107], a[164:167], v[196:199]
    v_cvt_pk_bf16_f32 v223, v190, v191
    v_mfma_f32_16x16x32_bf16 v[200:203], v[104:107], a[168:171], v[200:203]
    s_mov_b32 s81, s76
    v_mfma_f32_16x16x32_bf16 v[204:207], v[104:107], a[172:175], v[204:207]
    s_waitcnt vmcnt(13)
    buffer_store_dwordx4 v[220:223], v1, s[4:7], s81 offen
    v_mfma_f32_16x16x32_bf16 v[40:43], v[108:111], a[176:179], v[40:43]
    buffer_load_dwordx4 v[156:159], v1, s[4:7], s80 offen offset:3072 sc1
    v_mfma_f32_16x16x32_bf16 v[196:199], v[108:111], a[180:183], v[196:199]
    v_mfma_f32_16x16x32_bf16 v[200:203], v[108:111], a[184:187], v[200:203]
    v_mfma_f32_16x16x32_bf16 v[204:207], v[108:111], a[188:191], v[204:207]
    s_waitcnt vmcnt(14)
    s_lshl2_add_u32 s82, s66, 2
    s_waitcnt vmcnt(13)
    v_cmp_gt_u32 vcc, s82, v250
    s_cbranch_vccnz L_rt_30
L_bk_31:
    v_mfma_f32_16x16x32_bf16 v[40:43], v[112:115], a[192:195], v[40:43]
    s_add_u32 s80, s37, 8192
    buffer_load_dwordx4 v[64:67], v1, s[4:7], s80 offen offset:0 sc1
    v_mfma_f32_16x16x32_bf16 v[196:199], v[112:115], a[196:199], v[196:199]
    v_mfma_f32_16x16x32_bf16 v[200:203], v[112:115], a[200:203], v[200:203]
    v_mfma_f32_16x16x32_bf16 v[204:207], v[112:115], a[204:207], v[204:207]
    s_waitcnt vmcnt(13)
    v_mfma_f32_16x16x32_bf16 v[40:43], v[116:119], a[208:211], v[40:43]
    buffer_load_dwordx4 v[68:71], v1, s[4:7], s80 offen offset:1024 sc1
    v_mfma_f32_16x16x32_bf16 v[196:199], v[116:119], a[212:215], v[196:199]
    v_mfma_f32_16x16x32_bf16 v[200:203], v[116:119], a[216:219], v[200:203]
    v_mfma_f32_16x16x32_bf16 v[204:207], v[116:119], a[220:223], v[204:207]
    s_waitcnt vmcnt(13)
    v_mfma_f32_16x16x32_bf16 v[40:43], v[120:123], a[224:227], v[40:43]
    buffer_load_dwordx4 v[72:75], v1, s[4:7], s80 offen offset:2048 sc1
    v_mfma_f32_16x16x32_bf16 v[196:199], v[120:123], a[228:231], v[196:199]
    v_mfma_f32_16x16x32_bf16 v[200:203], v[120:123], a[232:235], v[200:203]
    v_mfma_f32_16x16x32_bf16 v[204:207], v[120:123], a[236:239], v[204:207]
    s_waitcnt vmcnt(13)
    v_mfma_f32_16x16x32_bf16 v[40:43], v[124:127], a[240:243], v[40:43]
    buffer_load_dwordx4 v[76:79], v1, s[4:7], s80 offen offset:3072 sc1
    v_mfma_f32_16x16x32_bf16 v[196:199], v[124:127], a[244:247], v[196:199]
    v_mfma_f32_16x16x32_bf16 v[200:203], v[124:127], a[248:251], v[200:203]
    v_mfma_f32_16x16x32_bf16 v[204:207], v[124:127], a[252:255], v[204:207]
    s_nop 5
    ds_write_b128 v235, v[196:199] offset:0
    ds_write_b128 v236, v[200:203] offset:0
    ds_write_b128 v237, v[204:207] offset:0
    s_add_u32 s77, s77, 0x101
    v_mov_b32 v251, s77
    s_waitcnt vmcnt(5)
    s_mov_b64 exec, 1
    buffer_store_short v251, off, s[4:7], s43 offset:64
    s_mov_b64 exec, -1
    s_waitcnt lgkmcnt(0)
    s_barrier
    ds_read_b128 v[188:191], v238 offset:0
    ds_read_b128 v[192:195], v238 offset:1024
    ds_read_b128 v[52:55], v238 offset:2048
    s_add_u32 s80, s37, 12288
    buffer_load_dwordx4 v[80:83], v1, s[4:7], s80 offen offset:0 sc1
    buffer_load_dwordx4 v[84:87], v1, s[4:7], s80 offen offset:1024 sc1
    buffer_load_dwordx4 v[88:91], v1, s[4:7], s80 offen offset:2048 sc1
    buffer_load_dwordx4 v[92:95], v1, s[4:7], s80 offen offset:3072 sc1
    s_waitcnt lgkmcnt(0)
    v_pk_add_f32 v[188:189], v[188:189], v[192:193]
    v_pk_add_f32 v[40:41], v[40:41], v[52:53]
    v_pk_add_f32 v[188:189], v[188:189], v[40:41]
    v_pk_mul_f32 v[188:189], v[188:189], v[184:185]
    v_pk_add_f32 v[190:191], v[190:191], v[194:195]
    v_pk_add_f32 v[42:43], v[42:43], v[54:55]
    v_pk_add_f32 v[190:191], v[190:191], v[42:43]
    v_pk_mul_f32 v[190:191], v[190:191], v[186:187]
    v_cvt_pk_bf16_f32 v224, v188, v189
    v_cvt_pk_bf16_f32 v225, v190, v191
    buffer_store_dwordx2 v[224:225], v1, s[4:7], s39 offen
    ds_read_b128 v[196:199], v5 offset:0
    ds_read_b128 v[200:203], v5 offset:1024
    ds_read_b128 v[204:207], v5 offset:2048
    ds_read_b128 v[208:211], v5 offset:3072
    ds_read_b128 v[212:215], v5 offset:4096
    ds_read_b128 v[216:219], v5 offset:5120
    ds_read_b128 v[220:223], v5 offset:6144
    s_waitcnt vmcnt(18) lgkmcnt(5)
    v_mfma_f32_16x16x32_bf16 v[16:19], v[196:199], v[128:131], v[16:19]
    ds_read_b128 v[224:227], v5 offset:7168
    v_mfma_f32_16x16x32_bf16 v[20:23], v[200:203], v[128:131], v[20:23]
    s_waitcnt lgkmcnt(4)
    ds_read_b128 v[196:199], v5 offset:8192
    v_mfma_f32_16x16x32_bf16 v[24:27], v[204:207], v[128:131], v[24:27]
    ds_read_b128 v[200:203], v5 offset:9216
    v_mfma_f32_16x16x32_bf16 v[28:31], v[208:211], v[128:131], v[28:31]
    s_waitcnt vmcnt(17) lgkmcnt(4)
    ds_read_b128 v[204:207], v5 offset:10240
    v_mfma_f32_16x16x32_bf16 v[16:19], v[212:215], v[132:135], v[16:19]
    ds_read_b128 v[208:211], v5 offset:11264
    v_mfma_f32_16x16x32_bf16 v[20:23], v[216:219], v[132:135], v[20:23]
    s_waitcnt lgkmcnt(4)
    ds_read_b128 v[212:215], v5 offset:12288
    v_mfma_f32_16x16x32_bf16 v[24:27], v[220:223], v[132:135], v[24:27]
    ds_read_b128 v[216:219], v5 offset:13312
    v_mfma_f32_16x16x32_bf16 v[28:31], v[224:227], v[132:135], v[28:31]
    s_waitcnt vmcnt(16) lgkmcnt(4)
    ds_read_b128 v[220:223], v5 offset:14336
    v_mfma_f32_16x16x32_bf16 v[16:19], v[196:199], v[136:139], v[16:19]
    ds_read_b128 v[224:227], v5 offset:15360
    buffer_load_ubyte v250, v2, s[4:7], s91 offen offset:64 sc1
    v_mfma_f32_16x16x32_bf16 v[20:23], v[200:203], v[136:139], v[20:23]
    s_waitcnt lgkmcnt(4)
    ds_read_b128 v[196:199], v5 offset:16384
    v_mfma_f32_16x16x32_bf16 v[24:27], v[204:207], v[136:139], v[24:27]
    ds_read_b128 v[200:203], v5 offset:17408
    v_mfma_f32_16x16x32_bf16 v[28:31], v[208:211], v[136:139], v[28:31]
    s_waitcnt vmcnt(16) lgkmcnt(4)
    ds_read_b128 v[204:207], v5 offset:18432
    v_mfma_f32_16x16x32_bf16 v[16:19], v[212:215], v[140:143], v[16:19]
    ds_read_b128 v[208:211], v5 offset:19456
    v_mfma_f32_16x16x32_bf16 v[20:23], v[216:219], v[140:143], v[20:23]
    s_waitcnt lgkmcnt(4)
    ds_read_b128 v[212:215], v5 offset:20480
    v_mfma_f32_16x16x32_bf16 v[24:27], v[220:223], v[140:143], v[24:27]
    ds_read_b128 v[216:219], v5 offset:21504
    v_mfma_f32_16x16x32_bf16 v[28:31], v[224:227], v[140:143], v[28:31]
    s_waitcnt vmcnt(15) lgkmcnt(4)
    ds_read_b128 v[220:223], v5 offset:22528
    v_mfma_f32_16x16x32_bf16 v[16:19], v[196:199], v[144:147], v[16:19]
    ds_read_b128 v[224:227], v5 offset:23552
    v_mfma_f32_16x16x32_bf16 v[20:23], v[200:203], v[144:147], v[20:23]
    s_waitcnt lgkmcnt(4)
    ds_read_b128 v[196:199], v5 offset:24576
    v_mfma_f32_16x16x32_bf16 v[24:27], v[204:207], v[144:147], v[24:27]
    ds_read_b128 v[200:203], v5 offset:25600
    v_mfma_f32_16x16x32_bf16 v[28:31], v[208:211], v[144:147], v[28:31]
    s_waitcnt vmcnt(14) lgkmcnt(4)
    ds_read_b128 v[204:207], v5 offset:26624
    v_mfma_f32_16x16x32_bf16 v[16:19], v[212:215], v[148:151], v[16:19]
    s_add_u32 s77, s77, 0x101
    ds_read_b128 v[208:211], v5 offset:27648
    v_mov_b32 v251, s77
    v_mfma_f32_16x16x32_bf16 v[20:23], v[216:219], v[148:151], v[20:23]
    s_waitcnt lgkmcnt(4)
    ds_read_b128 v[212:215], v5 offset:28672
    s_waitcnt vmcnt(1)
    s_mov_b64 exec, 1
    buffer_store_short v251, off, s[4:7], s43 offset:64
    s_mov_b64 exec, -1
    v_mfma_f32_16x16x32_bf16 v[24:27], v[220:223], v[148:151], v[24:27]
    ds_read_b128 v[216:219], v5 offset:29696
    v_mfma_f32_16x16x32_bf16 v[28:31], v[224:227], v[148:151], v[28:31]
    s_waitcnt vmcnt(14) lgkmcnt(4)
    ds_read_b128 v[220:223], v5 offset:30720
    v_mfma_f32_16x16x32_bf16 v[16:19], v[196:199], v[152:155], v[16:19]
    ds_read_b128 v[224:227], v5 offset:31744
    v_mfma_f32_16x16x32_bf16 v[20:23], v[200:203], v[152:155], v[20:23]
    s_waitcnt lgkmcnt(4)
    ds_read_b128 v[196:199], v5 offset:32768
    v_mfma_f32_16x16x32_bf16 v[24:27], v[204:207], v[152:155], v[24:27]
    ds_read_b128 v[200:203], v5 offset:33792
    v_mfma_f32_16x16x32_bf16 v[28:31], v[208:211], v[152:155], v[28:31]
    s_waitcnt vmcnt(12) lgkmcnt(4)
    ds_read_b128 v[204:207], v5 offset:34816
    v_mfma_f32_16x16x32_bf16 v[16:19], v[212:215], v[156:159], v[16:19]
    ds_read_b128 v[208:211], v5 offset:35840
    v_mfma_f32_16x16x32_bf16 v[20:23], v[216:219], v[156:159], v[20:23]
    s_waitcnt lgkmcnt(4)
    ds_read_b128 v[212:215], v5 offset:36864
    v_mfma_f32_16x16x32_bf16 v[24:27], v[220:223], v[156:159], v[24:27]
    ds_read_b128 v[216:219], v5 offset:37888
    v_mfma_f32_16x16x32_bf16 v[28:31], v[224:227], v[156:159], v[28:31]
    s_waitcnt vmcnt(11) lgkmcnt(4)
    ds_read_b128 v[220:223], v5 offset:38912
    v_mfma_f32_16x16x32_bf16 v[16:19], v[196:199], v[64:67], v[16:19]
    ds_read_b128 v[224:227], v5 offset:39936
    s_lshl2_add_u32 s82, s66, 3
    s_waitcnt vmcnt(1)
    v_cmp_gt_u32 vcc, s82, v250
    s_cbranch_vccnz L_rt_32
L_bk_33:
    v_mfma_f32_16x16x32_bf16 v[20:23], v[200:203], v[64:67], v[20:23]
    s_waitcnt lgkmcnt(4)
    ds_read_b128 v[196:199], v5 offset:40960
    s_add_u32 s80, s40, 0
    v_mfma_f32_16x16x32_bf16 v[24:27], v[204:207], v[64:67], v[24:27]
    ds_read_b128 v[200:203], v5 offset:41984
    buffer_load_dwordx4 v[96:99], v1, s[4:7], s80 offen offset:0 sc1
    v_mfma_f32_16x16x32_bf16 v[28:31], v[208:211], v[64:67], v[28:31]
    s_waitcnt vmcnt(11) lgkmcnt(4)
    ds_read_b128 v[204:207], v5 offset:43008
    v_mfma_f32_16x16x32_bf16 v[16:19], v[212:215], v[68:71], v[16:19]
    ds_read_b128 v[208:211], v5 offset:44032
    buffer_load_dwordx4 v[100:103], v1, s[4:7], s80 offen offset:1024 sc1
    v_mfma_f32_16x16x32_bf16 v[20:23], v[216:219], v[68:71], v[20:23]
    s_waitcnt lgkmcnt(4)
    ds_read_b128 v[212:215], v5 offset:45056
    v_mfma_f32_16x16x32_bf16 v[24:27], v[220:223], v[68:71], v[24:27]
    ds_read_b128 v[216:219], v5 offset:46080
    v_mfma_f32_16x16x32_bf16 v[28:31], v[224:227], v[68:71], v[28:31]
    s_waitcnt vmcnt(11) lgkmcnt(4)
    ds_read_b128 v[220:223], v5 offset:47104
    v_mfma_f32_16x16x32_bf16 v[16:19], v[196:199], v[72:75], v[16:19]
    s_barrier
    ds_read_b128 v[224:227], v5 offset:48128
    buffer_load_dwordx4 v[104:107], v1, s[4:7], s80 offen offset:2048 sc1
    v_mfma_f32_16x16x32_bf16 v[20:23], v[200:203], v[72:75], v[20:23]
    s_waitcnt lgkmcnt(4)
    ds_read_b128 v[196:199], v5 offset:49152
    buffer_load_ubyte v250, v2, s[4:7], s91 offen offset:64 sc1
    v_mfma_f32_16x16x32_bf16 v[24:27], v[204:207], v[72:75], v[24:27]
    ds_read_b128 v[200:203], v5 offset:50176
    v_mfma_f32_16x16x32_bf16 v[28:31], v[208:211], v[72:75], v[28:31]
    s_waitcnt vmcnt(12) lgkmcnt(4)
    ds_read_b128 v[204:207], v5 offset:51200
    v_mfma_f32_16x16x32_bf16 v[16:19], v[212:215], v[76:79], v[16:19]
    ds_read_b128 v[208:211], v5 offset:52224
    buffer_load_dwordx4 v[108:111], v1, s[4:7], s80 offen offset:3072 sc1
    v_mfma_f32_16x16x32_bf16 v[20:23], v[216:219], v[76:79], v[20:23]
    s_waitcnt lgkmcnt(4)
    ds_read_b128 v[212:215], v5 offset:53248
    v_mfma_f32_16x16x32_bf16 v[24:27], v[220:223], v[76:79], v[24:27]
    ds_read_b128 v[216:219], v5 offset:54272
    v_mfma_f32_16x16x32_bf16 v[28:31], v[224:227], v[76:79], v[28:31]
    s_waitcnt vmcnt(11) lgkmcnt(4)
    ds_read_b128 v[220:223], v5 offset:55296
    v_mfma_f32_16x16x32_bf16 v[16:19], v[196:199], v[80:83], v[16:19]
    s_add_u32 s80, s40, 4096
    ds_read_b128 v[224:227], v5 offset:56320
    buffer_load_dwordx4 v[112:115], v1, s[4:7], s80 offen offset:0 sc1
    v_mfma_f32_16x16x32_bf16 v[20:23], v[200:203], v[80:83], v[20:23]
    s_waitcnt lgkmcnt(4)
    ds_read_b128 v[196:199], v1 offset:0
    v_mfma_f32_16x16x32_bf16 v[24:27], v[204:207], v[80:83], v[24:27]
    ds_read_b128 v[200:203], v1 offset:1024
    v_mfma_f32_16x16x32_bf16 v[28:31], v[208:211], v[80:83], v[28:31]
    s_waitcnt vmcnt(11) lgkmcnt(4)
    ds_read_b128 v[204:207], v1 offset:2048
    v_mfma_f32_16x16x32_bf16 v[16:19], v[212:215], v[84:87], v[16:19]
    ds_read_b128 v[208:211], v1 offset:3072
    buffer_load_dwordx4 v[116:119], v1, s[4:7], s80 offen offset:1024 sc1
    v_mfma_f32_16x16x32_bf16 v[20:23], v[216:219], v[84:87], v[20:23]
    s_waitcnt lgkmcnt(4)
    ds_read_b128 v[212:215], v1 offset:4096
    v_mfma_f32_16x16x32_bf16 v[24:27], v[220:223], v[84:87], v[24:27]
    ds_read_b128 v[216:219], v1 offset:5120
    v_mfma_f32_16x16x32_bf16 v[28:31], v[224:227], v[84:87], v[28:31]
    s_waitcnt vmcnt(11) lgkmcnt(4)
    ds_read_b128 v[220:223], v1 offset:6144
    v_mfma_f32_16x16x32_bf16 v[16:19], v[196:199], v[88:91], v[16:19]
    ds_read_b128 v[224:227], v1 offset:7168
    buffer_load_dwordx4 v[120:123], v1, s[4:7], s80 offen offset:2048 sc1
    v_mfma_f32_16x16x32_bf16 v[20:23], v[200:203], v[88:91], v[20:23]
    s_waitcnt lgkmcnt(4)
    ds_read_b128 v[196:199], v1 offset:8192
    v_mfma_f32_16x16x32_bf16 v[24:27], v[204:207], v[88:91], v[24:27]
    ds_read_b128 v[200:203], v1 offset:9216
    v_mfma_f32_16x16x32_bf16 v[28:31], v[208:211], v[88:91], v[28:31]
    s_waitcnt vmcnt(11) lgkmcnt(4)
    ds_read_b128 v[204:207], v1 offset:10240
    v_mfma_f32_16x16x32_bf16 v[16:19], v[212:215], v[92:95], v[16:19]
    ds_read_b128 v[208:211], v1 offset:11264
    buffer_load_dwordx4 v[124:127], v1, s[4:7], s80 offen offset:3072 sc1
    v_mfma_f32_16x16x32_bf16 v[20:23], v[216:219], v[92:95], v[20:23]
    s_waitcnt lgkmcnt(4)
    ds_read_b128 v[212:215], v1 offset:12288
    v_mfma_f32_16x16x32_bf16 v[24:27], v[220:223], v[92:95], v[24:27]
    ds_read_b128 v[216:219], v1 offset:13312
    v_mfma_f32_16x16x32_bf16 v[28:31], v[224:227], v[92:95], v[28:31]
    s_waitcnt vmcnt(8) lgkmcnt(4)
    ds_read_b128 v[220:223], v1 offset:14336
    v_mfma_f32_16x16x32_bf16 v[16:19], v[196:199], v[96:99], v[16:19]
    ds_read_b128 v[224:227], v1 offset:15360
    s_lshl2_add_u32 s82, s66, 4
    s_waitcnt vmcnt(5)
    v_cmp_gt_u32 vcc, s82, v250
    s_cbranch_vccnz L_rt_34
L_bk_35:
    v_mfma_f32_16x16x32_bf16 v[20:23], v[200:203], v[96:99], v[20:23]
    s_waitcnt lgkmcnt(4)
    ds_read_b128 v[196:199], v1 offset:16384
    s_add_u32 s80, s40, 8192
    v_mfma_f32_16x16x32_bf16 v[24:27], v[204:207], v[96:99], v[24:27]
    ds_read_b128 v[200:203], v1 offset:17408
    buffer_load_dwordx4 v[128:131], v1, s[4:7], s80 offen offset:0 sc1
    v_mfma_f32_16x16x32_bf16 v[28:31], v[208:211], v[96:99], v[28:31]
    s_waitcnt vmcnt(8) lgkmcnt(4)
    ds_read_b128 v[204:207], v1 offset:18432
    v_mfma_f32_16x16x32_bf16 v[16:19], v[212:215], v[100:103], v[16:19]
    ds_read_b128 v[208:211], v1 offset:19456
    buffer_load_dwordx4 v[132:135], v1, s[4:7], s80 offen offset:1024 sc1
    v_mfma_f32_16x16x32_bf16 v[20:23], v[216:219], v[100:103], v[20:23]
    s_waitcnt lgkmcnt(4)
    ds_read_b128 v[212:215], v1 offset:20480
    v_mfma_f32_16x16x32_bf16 v[24:27], v[220:223], v[100:103], v[24:27]
    ds_read_b128 v[216:219], v1 offset:21504
    v_mfma_f32_16x16x32_bf16 v[28:31], v[224:227], v[100:103], v[28:31]
    s_waitcnt vmcnt(8) lgkmcnt(4)
    ds_read_b128 v[220:223], v1 offset:22528
    v_mfma_f32_16x16x32_bf16 v[16:19], v[196:199], v[104:107], v[16:19]
    ds_read_b128 v[224:227], v1 offset:23552
    buffer_load_dwordx4 v[136:139], v1, s[4:7], s80 offen offset:2048 sc1
    v_mfma_f32_16x16x32_bf16 v[20:23], v[200:203], v[104:107], v[20:23]
    s_waitcnt lgkmcnt(4)
    ds_read_b128 v[196:199], v1 offset:24576
    v_mfma_f32_16x16x32_bf16 v[24:27], v[204:207], v[104:107], v[24:27]
    ds_read_b128 v[200:203], v1 offset:25600
    v_mfma_f32_16x16x32_bf16 v[28:31], v[208:211], v[104:107], v[28:31]
    s_waitcnt vmcnt(7) lgkmcnt(4)
    ds_read_b128 v[204:207], v1 offset:26624
    v_mfma_f32_16x16x32_bf16 v[16:19], v[212:215], v[108:111], v[16:19]
    ds_read_b128 v[208:211], v1 offset:27648
    buffer_load_dwordx4 v[140:143], v1, s[4:7], s80 offen offset:3072 sc1
    v_mfma_f32_16x16x32_bf16 v[20:23], v[216:219], v[108:111], v[20:23]
    s_waitcnt lgkmcnt(4)
    ds_read_b128 v[212:215], v1 offset:28672
    v_mfma_f32_16x16x32_bf16 v[24:27], v[220:223], v[108:111], v[24:27]
    ds_read_b128 v[216:219], v1 offset:29696
    v_mfma_f32_16x16x32_bf16 v[28:31], v[224:227], v[108:111], v[28:31]
    s_waitcnt vmcnt(7) lgkmcnt(4)
    ds_read_b128 v[220:223], v1 offset:30720
    v_mfma_f32_16x16x32_bf16 v[16:19], v[196:199], v[112:115], v[16:19]
    s_add_u32 s85, s73, 1024
    ds_read_b128 v[224:227], v1 offset:31744
    s_add_u32 m0, s60, 125184
    v_mfma_f32_16x16x32_bf16 v[20:23], v[200:203], v[112:115], v[20:23]
    s_waitcnt lgkmcnt(4)
    ds_read_b128 v[196:199], v1 offset:32768
    buffer_load_dwordx4 v252, s[8:11], s85 offen lds
    v_mfma_f32_16x16x32_bf16 v[24:27], v[204:207], v[112:115], v[24:27]
    ds_read_b128 v[200:203], v1 offset:33792
    v_mfma_f32_16x16x32_bf16 v[28:31], v[208:211], v[112:115], v[28:31]
    s_waitcnt vmcnt(7) lgkmcnt(4)
    ds_read_b128 v[204:207], v1 offset:34816
    v_mfma_f32_16x16x32_bf16 v[16:19], v[212:215], v[116:119], v[16:19]
    s_add_u32 s85, s73, 3072
    ds_read_b128 v[208:211], v1 offset:35840
    s_add_u32 m0, s60, 126240
    v_mfma_f32_16x16x32_bf16 v[20:23], v[216:219], v[116:119], v[20:23]
    s_waitcnt lgkmcnt(4)
    ds_read_b128 v[212:215], v1 offset:36864
    buffer_load_dwordx4 v252, s[8:11], s85 offen lds
    v_mfma_f32_16x16x32_bf16 v[24:27], v[220:223], v[116:119], v[24:27]
    ds_read_b128 v[216:219], v1 offset:37888
    v_mfma_f32_16x16x32_bf16 v[28:31], v[224:227], v[116:119], v[28:31]
    s_waitcnt vmcnt(7) lgkmcnt(4)
    ds_read_b128 v[220:223], v1 offset:38912
    v_mfma_f32_16x16x32_bf16 v[16:19], v[196:199], v[120:123], v[16:19]
    s_add_u32 s85, s73, 5120
    ds_read_b128 v[224:227], v1 offset:39936
    s_add_u32 m0, s60, 127296
    v_mfma_f32_16x16x32_bf16 v[20:23], v[200:203], v[120:123], v[20:23]
    s_waitcnt lgkmcnt(4)
    ds_read_b128 v[196:199], v1 offset:40960
    buffer_load_dwordx4 v252, s[8:11], s85 offen lds
    v_mfma_f32_16x16x32_bf16 v[24:27], v[204:207], v[120:123], v[24:27]
    ds_read_b128 v[200:203], v1 offset:41984
    v_mfma_f32_16x16x32_bf16 v[28:31], v[208:211], v[120:123], v[28:31]
    s_waitcnt vmcnt(7) lgkmcnt(4)
    ds_read_b128 v[204:207], v1 offset:43008
    v_mfma_f32_16x16x32_bf16 v[16:19], v[212:215], v[124:127], v[16:19]
    s_add_u32 s85, s73, 7168
    ds_read_b128 v[208:211], v1 offset:44032
    s_add_u32 m0, s60, 128352
    v_mfma_f32_16x16x32_bf16 v[20:23], v[216:219], v[124:127], v[20:23]
    s_waitcnt lgkmcnt(4)
    ds_read_b128 v[212:215], v1 offset:45056
    buffer_load_dwordx4 v252, s[8:11], s85 offen lds
    v_mfma_f32_16x16x32_bf16 v[24:27], v[220:223], v[124:127], v[24:27]
    ds_read_b128 v[216:219], v1 offset:46080
    v_mfma_f32_16x16x32_bf16 v[28:31], v[224:227], v[124:127], v[28:31]
    s_waitcnt vmcnt(7) lgkmcnt(4)
    ds_read_b128 v[220:223], v1 offset:47104
    v_mfma_f32_16x16x32_bf16 v[16:19], v[196:199], v[128:131], v[16:19]
    ds_read_b128 v[224:227], v1 offset:48128
    v_mfma_f32_16x16x32_bf16 v[20:23], v[200:203], v[128:131], v[20:23]
    s_waitcnt lgkmcnt(4)
    ds_read_b128 v[196:199], v1 offset:49152
    v_mfma_f32_16x16x32_bf16 v[24:27], v[204:207], v[128:131], v[24:27]
    ds_read_b128 v[200:203], v1 offset:50176
    v_mfma_f32_16x16x32_bf16 v[28:31], v[208:211], v[128:131], v[28:31]
    s_waitcnt vmcnt(6) lgkmcnt(4)
    ds_read_b128 v[204:207], v1 offset:51200
    v_mfma_f32_16x16x32_bf16 v[16:19], v[212:215], v[132:135], v[16:19]
    ds_read_b128 v[208:211], v1 offset:52224
    v_mfma_f32_16x16x32_bf16 v[20:23], v[216:219], v[132:135], v[20:23]
    s_waitcnt lgkmcnt(4)
    ds_read_b128 v[212:215], v1 offset:53248
    v_mfma_f32_16x16x32_bf16 v[24:27], v[220:223], v[132:135], v[24:27]
    ds_read_b128 v[216:219], v1 offset:54272
    v_mfma_f32_16x16x32_bf16 v[28:31], v[224:227], v[132:135], v[28:31]
    s_waitcnt vmcnt(5) lgkmcnt(4)
    ds_read_b128 v[220:223], v1 offset:55296
    v_mfma_f32_16x16x32_bf16 v[16:19], v[196:199], v[136:139], v[16:19]
    ds_read_b128 v[224:227], v1 offset:56320
    v_mfma_f32_16x16x32_bf16 v[20:23], v[200:203], v[136:139], v[20:23]
    s_waitcnt lgkmcnt(4)
    v_mfma_f32_16x16x32_bf16 v[24:27], v[204:207], v[136:139], v[24:27]
    v_mfma_f32_16x16x32_bf16 v[28:31], v[208:211], v[136:139], v[28:31]
    s_waitcnt vmcnt(4) lgkmcnt(2)
    v_mfma_f32_16x16x32_bf16 v[16:19], v[212:215], v[140:143], v[16:19]
    v_mfma_f32_16x16x32_bf16 v[20:23], v[216:219], v[140:143], v[20:23]
    s_waitcnt lgkmcnt(0)
    v_mfma_f32_16x16x32_bf16 v[24:27], v[220:223], v[140:143], v[24:27]
    v_mfma_f32_16x16x32_bf16 v[28:31], v[224:227], v[140:143], v[28:31]
    s_nop 3
    v_cvt_pk_bf16_f32 v32, v16, v17
    v_cvt_pk_bf16_f32 v33, v18, v19
    v_cvt_pk_bf16_f32 v34, v20, v21
    v_cvt_pk_bf16_f32 v35, v22, v23
    v_cvt_pk_bf16_f32 v36, v24, v25
    v_cvt_pk_bf16_f32 v37, v26, v27
    v_cvt_pk_bf16_f32 v38, v28, v29
    v_cvt_pk_bf16_f32 v39, v30, v31
    s_cmp_eq_u32 s66, 1
    s_cbranch_scc1 L_fin
    buffer_store_dwordx4 v[32:35], v1, s[4:7], s41 offen
    buffer_store_dwordx4 v[36:39], v1, s[4:7], s41 offen offset:1024
    v_dot2_f32_bf16 v12, v32, s71, 0
    v_dot2_f32_bf16 v13, v32, v32, 0
    v_dot2_f32_bf16 v14, v36, s71, 0
    v_dot2_f32_bf16 v15, v36, v36, 0
    v_dot2c_f32_bf16 v12, s71, v33
    v_dot2c_f32_bf16 v13, v33, v33
    v_dot2c_f32_bf16 v14, s71, v37
    v_dot2c_f32_bf16 v15, v37, v37
    v_dot2c_f32_bf16 v12, s71, v34
    v_dot2c_f32_bf16 v13, v34, v34
    v_dot2c_f32_bf16 v14, s71, v38
    v_dot2c_f32_bf16 v15, v38, v38
    v_dot2c_f32_bf16 v12, s71, v35
    v_dot2c_f32_bf16 v13, v35, v35
    v_dot2c_f32_bf16 v14, s71, v39
    v_dot2c_f32_bf16 v15, v39, v39
    s_nop 0
    v_permlane32_swap_b32 v12, v13
    s_nop 0
    v_permlane32_swap_b32 v14, v15
    v_add_f32 v12, v12, v13
    v_add_f32 v14, v14, v15
    s_nop 1
    v_permlane16_swap_b32 v12, v14
    v_add_f32 v12, v12, v14
    v_and_or_b32 v14, v12, -4, 1
    s_mov_b32 s66, 1
    s_mov_b32 s54, 2
    s_mov_b32 s55, 2
    s_mov_b32 s10, 0
    s_add_u32 s34, s34, 131072
    s_add_u32 s28, s28, 6291456
    s_add_u32 s32, s32, 6291456
    s_add_u32 s33, s33, 6291456
    s_add_u32 s92, s92, 6291456
    s_add_u32 s36, s36, 6291456
    s_add_u32 s40, s40, 6291456
    s_add_u32 s39, s39, 6291456
    s_add_u32 s76, s76, 6291456
    s_waitcnt vmcnt(0)
    buffer_store_dword v14, v239, s[4:7], s42 offen
    s_barrier
    buffer_load_dwordx4 v[44:47], v1, s[4:7], s46 offen offset:0 sc1
    buffer_load_dwordx4 v[48:51], v1, s[4:7], s46 offen offset:1024 sc1
    s_waitcnt vmcnt(0)
    v_xor_b32 v12, v44, v45
    v_xor_b32 v13, v44, v46
    v_xor_b32 v14, v44, v47
    v_xor_b32 v15, 1, v44
    v_or3_b32 v12, v12, v13, v14
    v_xor_b32 v13, v44, v48
    v_xor_b32 v14, v44, v49
    v_or3_b32 v15, v15, v13, v14
    v_xor_b32 v13, v44, v50
    v_xor_b32 v14, v44, v51
    v_or3_b32 v12, v12, v13, v14
    v_bitop3_b32 v12, v12, v15, 3 bitop3:0xa8
    v_cmp_ne_u32 vcc, 0, v12
    s_cbranch_vccnz L_rt_36
L_bk_37:
    s_branch L_iter
L_fin:
    buffer_store_dwordx4 v[32:35], v241, s[20:23], s44 offen
    buffer_store_dwordx4 v[36:39], v241, s[20:23], s44 offen offset:64
    s_cmp_eq_u32 s68, 0
    s_cbranch_scc1 L_skip_38
    s_mov_b32 s12, s58
    s_mov_b32 s13, s59
    s_mov_b32 s14, 0x100
    s_mov_b32 s15, 0x20000
    v_mov_b32 v12, s68
    s_mov_b64 exec, 1
    buffer_store_dword v12, off, s[12:15], 0 offset:4
L_skip_38:
L_end:
    s_endpgm
L_rt_5:
    buffer_load_dword v250, off, s[24:27], 0 offset:8 sc1
    s_waitcnt vmcnt(0)
    v_cmp_gt_u32 vcc, 1, v250
    s_cbranch_vccz L_bk_6
    s_sub_u32 s67, s67, 1
    s_cbranch_scc0 L_rt_5
    s_mov_b32 s67, 0
    s_mov_b32 s68, 1
    s_branch L_bk_6
L_rt_8:
    buffer_load_dwordx2 v[250:251], v59, s[4:7], s75 offen sc1
    s_waitcnt vmcnt(0)
    v_cmp_gt_u32 vcc, 0x2000, v251
    s_cbranch_vccz L_bk_9
    s_sub_u32 s67, s67, 1
    s_cbranch_scc0 L_rt_8
    s_mov_b32 s67, 0
    s_mov_b32 s68, 8
    s_branch L_bk_9
L_fix:
    s_mov_b32 s77, -1
    v_mov_b32 v250, 159872
    s_cmp_lg_u32 s62, 0
    s_cbranch_scc1 L_fix1
    s_lshl_b32 s78, s70, 5
    v_mov_b32 v251, 1
    s_mov_b64 exec, 1
    buffer_atomic_add v251, off, s[24:27], s78 sc0 sc1
    s_waitcnt vmcnt(0)
    ds_write_b32 v250, v251
    s_mov_b64 exec, -1
L_fix1:
    s_waitcnt vmcnt(0) lgkmcnt(0)
    s_barrier
    ds_read_b32 v251, v250
    s_waitcnt lgkmcnt(0)
    v_readfirstlane_b32 s74, v251
    s_cmp_ge_u32 s74, 32
    s_cbranch_scc1 L_end
    s_bfe_u32 s78, s74, 0x10003
    s_lshl3_add_u32 s78, s78, s70
    s_bfe_u32 s79, s74, 0x10004
    s_lshl_b32 s79, s79, 8
    s_add_u32 s78, s78, s79
    s_lshl4_add_u32 s78, s78, s62
    s_add_u32 s79, s62, 0
    s_and_b32 s79, s79, 3
    s_lshl2_add_u32 s79, s79, s78
    s_lshl_b32 s48, s79, 10
    s_add_u32 s79, s62, 1
    s_and_b32 s79, s79, 3
    s_lshl2_add_u32 s79, s79, s78
    s_lshl_b32 s49, s79, 10
    s_add_u32 s79, s62, 2
    s_and_b32 s79, s79, 3
    s_lshl2_add_u32 s79, s79, s78
    s_lshl_b32 s50, s79, 10
    s_add_u32 s79, s62, 3
    s_and_b32 s79, s79, 3
    s_lshl2_add_u32 s79, s79, s78
    s_lshl_b32 s51, s79, 10
    s_branch L_stage
L_rt_10:
    buffer_load_dword v250, v230, s[4:7], s33 offen sc1
    s_add_u32 s78, s32, 0
    buffer_load_dwordx4 v[96:99], v228, s[4:7], s78 offen offset:0 sc1
    buffer_load_dwordx4 v[100:103], v228, s[4:7], s78 offen offset:2048 sc1
    s_add_u32 s78, s32, 16384
    buffer_load_dwordx4 v[104:107], v228, s[4:7], s78 offen offset:0 sc1
    buffer_load_dwordx4 v[108:111], v228, s[4:7], s78 offen offset:2048 sc1
    s_add_u32 s78, s32, 32768
    buffer_load_dwordx4 v[112:115], v228, s[4:7], s78 offen offset:0 sc1
    buffer_load_dwordx4 v[116:119], v228, s[4:7], s78 offen offset:2048 sc1
    s_add_u32 s78, s32, 49152
    buffer_load_dwordx4 v[120:123], v228, s[4:7], s78 offen offset:0 sc1
    buffer_load_dwordx4 v[124:127], v228, s[4:7], s78 offen offset:2048 sc1
    s_waitcnt vmcnt(0)
    v_max3_u32 v12, v250, v96, v98
    v_max3_u32 v12, v12, v100, v102
    v_max3_u32 v12, v12, v104, v106
    v_max3_u32 v12, v12, v108, v110
    v_max3_u32 v12, v12, v112, v114
    v_max3_u32 v12, v12, v116, v118
    v_max3_u32 v12, v12, v120, v122
    v_max3_u32 v12, v12, v124, v126
    v_cmp_eq_u32 vcc, -1, v12
    s_cbranch_vccz L_bk_11
    s_sub_u32 s67, s67, 1
    s_cbranch_scc0 L_rt_10
    s_mov_b32 s67, 0
    s_mov_b32 s68, 2
    s_branch L_bk_11
L_redo_14:
    s_cmp_eq_u32 s67, 0
    s_cbranch_scc1 L_gu_16
    buffer_load_dword v250, v230, s[4:7], s33 offen sc1
    s_add_u32 s78, s32, 0
    buffer_load_dwordx4 v[96:99], v228, s[4:7], s78 offen offset:0 sc1
    buffer_load_dwordx4 v[100:103], v228, s[4:7], s78 offen offset:2048 sc1
    s_add_u32 s78, s32, 16384
    buffer_load_dwordx4 v[104:107], v228, s[4:7], s78 offen offset:0 sc1
    buffer_load_dwordx4 v[108:111], v228, s[4:7], s78 offen offset:2048 sc1
    s_add_u32 s78, s32, 32768
    buffer_load_dwordx4 v[112:115], v228, s[4:7], s78 offen offset:0 sc1
    buffer_load_dwordx4 v[116:119], v228, s[4:7], s78 offen offset:2048 sc1
    s_add_u32 s78, s32, 49152
    buffer_load_dwordx4 v[120:123], v228, s[4:7], s78 offen offset:0 sc1
    buffer_load_dwordx4 v[124:127], v228, s[4:7], s78 offen offset:2048 sc1
    s_waitcnt vmcnt(0)
    v_max3_u32 v12, v250, v96, v98
    v_max3_u32 v12, v12, v100, v102
    v_max3_u32 v12, v12, v104, v106
    v_max3_u32 v12, v12, v108, v110
    v_max3_u32 v12, v12, v112, v114
    v_max3_u32 v12, v12, v116, v118
    v_max3_u32 v12, v12, v120, v122
    v_max3_u32 v12, v12, v124, v126
    v_cmp_eq_u32 vcc, -1, v12
    s_cbranch_vccz L_ok_15
    s_sub_u32 s67, s67, 1
    s_cmp_lg_u32 s67, 0
    s_cbranch_scc1 L_redo_14
    s_mov_b32 s68, 2
L_ok_15:
    v_lshlrev_b32 v16, 16, v44
    v_and_b32 v20, 0xffff0000, v44
    v_lshlrev_b32 v17, 16, v45
    v_and_b32 v21, 0xffff0000, v45
    v_lshlrev_b32 v18, 16, v46
    v_and_b32 v22, 0xffff0000, v46
    v_lshlrev_b32 v19, 16, v47
    v_and_b32 v23, 0xffff0000, v47
    v_mov_b32 v54, v16
    v_lshlrev_b32 v24, 16, v48
    v_and_b32 v28, 0xffff0000, v48
    v_lshlrev_b32 v25, 16, v49
    v_and_b32 v29, 0xffff0000, v49
    v_lshlrev_b32 v26, 16, v50
    v_and_b32 v30, 0xffff0000, v50
    v_lshlrev_b32 v27, 16, v51
    v_and_b32 v31, 0xffff0000, v51
    v_mov_b32 v55, v24
    s_branch L_p1j_4
L_rt_19:
    buffer_load_dwordx4 v[44:47], v1, s[4:7], s90 offen offset:0 sc1
    buffer_load_dwordx4 v[48:51], v1, s[4:7], s90 offen offset:1024 sc1
    s_waitcnt vmcnt(0)
    v_xor_b32 v12, v44, v45
    v_xor_b32 v13, v44, v46
    v_xor_b32 v14, v44, v47
    v_xor_b32 v15, s54, v44
    v_or3_b32 v12, v12, v13, v14
    v_xor_b32 v13, v44, v48
    v_xor_b32 v14, v44, v49
    v_or3_b32 v15, v15, v13, v14
    v_xor_b32 v13, v44, v50
    v_xor_b32 v14, v44, v51
    v_or3_b32 v12, v12, v13, v14
    v_bitop3_b32 v12, v12, v15, 3 bitop3:0xa8
    v_cmp_ne_u32 vcc, 0, v12
    s_cbranch_vccz L_bk_20
    s_sub_u32 s67, s67, 1
    s_cbranch_scc0 L_rt_19
    s_mov_b32 s67, 0
    s_mov_b32 s68, 3
    s_branch L_bk_20
L_rt_21:
    buffer_load_dwordx4 v[44:47], v1, s[4:7], s34 offen sc1
    s_waitcnt vmcnt(0)
    v_max3_u32 v12, v44, v45, v46
    v_max_u32 v12, v12, v47
    v_cmp_eq_u32 vcc, -1, v12
    s_cbranch_vccz L_bk_22
    s_sub_u32 s67, s67, 1
    s_cbranch_scc0 L_rt_21
    s_mov_b32 s67, 0
    s_mov_b32 s68, 4
    s_branch L_bk_22
L_rt_24:
    buffer_load_ubyte v250, v0, s[4:7], s94 offen offset:0 sc1
    s_waitcnt vmcnt(0)
    v_cmp_gt_u32 vcc, s55, v250
    s_cbranch_vccz L_bk_25
    s_sub_u32 s67, s67, 1
    s_cbranch_scc0 L_rt_24
    s_mov_b32 s67, 0
    s_mov_b32 s68, 5
    s_branch L_bk_25
L_rt_28:
    buffer_load_ubyte v250, v2, s[4:7], s91 offen offset:64 sc1
    s_waitcnt vmcnt(0)
    v_cmp_gt_u32 vcc, s82, v250
    s_cbranch_vccz L_bk_29
    s_sub_u32 s67, s67, 1
    s_cbranch_scc0 L_rt_28
    s_mov_b32 s67, 0
    s_mov_b32 s68, 6
    s_branch L_bk_29
L_rt_30:
    buffer_load_ubyte v250, v2, s[4:7], s91 offen offset:64 sc1
    s_waitcnt vmcnt(0)
    v_cmp_gt_u32 vcc, s82, v250
    s_cbranch_vccz L_bk_31
    s_sub_u32 s67, s67, 1
    s_cbranch_scc0 L_rt_30
    s_mov_b32 s67, 0
    s_mov_b32 s68, 6
    s_branch L_bk_31
L_rt_32:
    buffer_load_ubyte v250, v2, s[4:7], s91 offen offset:64 sc1
    s_waitcnt vmcnt(0)
    v_cmp_gt_u32 vcc, s82, v250
    s_cbranch_vccz L_bk_33
    s_sub_u32 s67, s67, 1
    s_cbranch_scc0 L_rt_32
    s_mov_b32 s67, 0
    s_mov_b32 s68, 6
    s_branch L_bk_33
L_rt_34:
    buffer_load_ubyte v250, v2, s[4:7], s91 offen offset:64 sc1
    s_waitcnt vmcnt(0)
    v_cmp_gt_u32 vcc, s82, v250
    s_cbranch_vccz L_bk_35
    s_sub_u32 s67, s67, 1
    s_cbranch_scc0 L_rt_34
    s_mov_b32 s67, 0
    s_mov_b32 s68, 6
    s_branch L_bk_35
L_rt_36:
    buffer_load_dwordx4 v[44:47], v1, s[4:7], s46 offen offset:0 sc1
    buffer_load_dwordx4 v[48:51], v1, s[4:7], s46 offen offset:1024 sc1
    s_waitcnt vmcnt(0)
    v_xor_b32 v12, v44, v45
    v_xor_b32 v13, v44, v46
    v_xor_b32 v14, v44, v47
    v_xor_b32 v15, 1, v44
    v_or3_b32 v12, v12, v13, v14
    v_xor_b32 v13, v44, v48
    v_xor_b32 v14, v44, v49
    v_or3_b32 v15, v15, v13, v14
    v_xor_b32 v13, v44, v50
    v_xor_b32 v14, v44, v51
    v_or3_b32 v12, v12, v13, v14
    v_bitop3_b32 v12, v12, v15, 3 bitop3:0xa8
    v_cmp_ne_u32 vcc, 0, v12
    s_cbranch_vccz L_bk_37
    s_sub_u32 s67, s67, 1
    s_cbranch_scc0 L_rt_36
    s_mov_b32 s67, 0
    s_mov_b32 s68, 7
    s_branch L_bk_37
L_last:
.section .rodata,"a"
.p2align 6
.amdhsa_kernel interleave_layers__spectral_fnet__mixer_gmlp__prompt_kernel
  .amdhsa_next_free_vgpr 512
  .amdhsa_next_free_sgpr 102
  .amdhsa_accum_offset 256
  .amdhsa_group_segment_fixed_size 0
  .amdhsa_kernarg_size 104
  .amdhsa_user_sgpr_count 2
  .amdhsa_user_sgpr_kernarg_segment_ptr 1
  .amdhsa_system_sgpr_workgroup_id_x 1
  .amdhsa_float_denorm_mode_32 3
.end_amdhsa_kernel
```
